```python
import torch

def _softmax(x, axis=-1):
    return torch.softmax(x, dim=axis)
def _gelu(x):
    return torch.nn.functional.gelu(x, approximate="tanh")
def _silu(x):
    return torch.nn.functional.silu(x)
def _sigmoid(x):
    return torch.sigmoid(x)
def _layernorm(x, axis=-1, eps=1e-5):
    m = x.mean(dim=axis, keepdim=True)
    v = x.var(dim=axis, keepdim=True, unbiased=False)
    return (x - m) / torch.sqrt(v + eps)
def _scatter_add(tgt, idx, src, axis=0):
    return tgt.clone().index_add_(axis, idx, src)
def _segment_sum(src, seg, n):
    out = torch.zeros((n,) + src.shape[1:], dtype=src.dtype)
    return out.index_add_(0, seg, src)
def _pad(x, pw):
    flat = tuple(v for pair in reversed(pw) for v in pair)
    return torch.nn.functional.pad(x, flat)

kernel_name = 'gather_scatter__edge_featured_mpnn_mpnn__graph'

def setup_inputs():

    _w = (lambda a: (lambda t: t.to(torch.bfloat16) if t.is_floating_point() else t)(torch.as_tensor(a)))
    N, deg, D, De = 10000, 64, 64, max(4, 1)
    E = N * deg
    H = 2 * D
    return {
        "x": _w((lambda *s: torch.randn(*s, dtype=torch.bfloat16) * 0.05)(N, D)),
        "e_attr": _w((lambda *s: torch.randn(*s, dtype=torch.bfloat16) * 1.6)(E, De)),
        "src": _w((lambda lo, hi, *s: torch.randint(lo, hi, s))(0, N, E).to(torch.int64)),
        "dst": _w((lambda lo, hi, *s: torch.randint(lo, hi, s))(0, N, E).to(torch.int64)),
        "w1": _w((lambda *s: torch.randn(*s, dtype=torch.bfloat16) * 1.6)(2 * D + De, H) * (1.0 / (2 * D + De) ** 0.5)),
        "b1": _w((lambda *s: torch.randn(*s, dtype=torch.bfloat16) * 3.2)(H) * 0.01),
        "w2": _w((lambda *s: torch.randn(*s, dtype=torch.bfloat16) * 0.05)(H, D) * (1.0 / H ** 0.5)),
        "b2": _w((lambda *s: torch.randn(*s, dtype=torch.bfloat16) * 0.05)(D) * 0.01),
    }

def reference(x, e_attr, src, dst, w1, b1, w2, b2):
    N, D = x.shape
    h_src = x[src]
    h_dst = x[dst]
    m_in = torch.concatenate([h_src, h_dst, e_attr], axis=-1)
    h = _silu(m_in @ w1 + b1)
    msg = h @ w2 + b2
    return _segment_sum(msg, dst, N)
```

```asm
; @launch grid=(256,1,1) block=(1024,1,1) lds=161296
.amdgcn_target "amdgcn-amd-amdhsa--gfx950"
.text
.globl gather_scatter__edge_featured_mpnn_mpnn__graph_kernel
.p2align 8
.type gather_scatter__edge_featured_mpnn_mpnn__graph_kernel,@function
gather_scatter__edge_featured_mpnn_mpnn__graph_kernel:
    s_getpc_b64 s[26:27]
K_PC2:
    v_lshlrev_b32 v3, 7, v0
    v_cmp_gt_u32 vcc, K_HOT_END-K_PC2, v3
    s_and_b64 exec, exec, vcc
    s_cbranch_execz K_NOCP
    global_load_dword v13, v3, s[26:27]
K_NOCP:
    s_mov_b64 exec, -1
    s_cmp_ge_u32 s2, 256
    s_cbranch_scc1 K_END
    s_load_dwordx16 s[4:19], s[0:1], 0
    s_load_dwordx4 s[20:23], s[0:1], 64
    s_load_dwordx2 s[24:25], s[0:1], 80
    v_lshlrev_b32 v2, 4, v0
    v_lshrrev_b32 v3, 6, v0
    s_mul_i32 s81, s2, 10000
    v_readfirstlane_b32 s78, v3
    v_min_u32 v4, 9984, v2
    v_add_u32 v46, s81, v4
    s_and_b32 s76, s2, 7
    s_lshr_b32 s89, s2, 3
    s_lshl4_add_u32 s89, s76, s89
    s_lshl4_add_u32 s76, s76, s89
    v_xor_b32 v3, v0, v2
    v_and_b32 v3, 0x70, v3
    v_lshrrev_b32 v5, 3, v0
    v_lshl_add_u32 v3, v5, 15, v3
    s_lshl_b32 s89, s76, 7
    s_sub_u32 s89, s89, 2621440
    v_add_u32 v3, s89, v3
    v_min_u32 v3, 1279984, v3
    v_and_b32 v5, 0x30, v0
    v_lshlrev_b32 v5, 2, v5
    v_xor_b32 v5, v5, v2
    s_mul_i32 s89, s78, 1040
    s_add_u32 m0, s89, 84336
    s_lshl_b32 s90, s78, 10
    s_sub_u32 s89, s78, 10
    s_waitcnt lgkmcnt(0)
    s_cbranch_scc0 K_XL
    global_load_dwordx4 v[60:63], v46, s[10:11]
K_XL:
    s_cmp_lt_u32 s89, 5
    s_cbranch_scc0 K_XM
    global_load_lds_dwordx4 v3, s[4:5]
K_XM:
    s_add_u32 m0, s90, 117408
    v_and_b32 v1, 63, v0
    global_load_lds_dwordx4 v5, s[12:13]
    v_lshlrev_b32 v8, 4, v1
K_XD:
    v_mov_b64 v[42:43], 0
    v_mov_b64 v[44:45], 0
    v_add_u32 v17, 114336, v8
    ds_write_b128 v17, v[42:45]
    ds_write_b128 v17, v[42:45] offset:2048
    s_cmp_ge_u32 s78, 10
    s_cbranch_scc1 K_NOSRC
    global_load_dwordx4 v[64:67], v46, s[8:9]
K_NOSRC:
    s_cmp_lg_u32 s78, 15
    s_cbranch_scc1 K_NOWCL
    v_add_u32 v3, 32768, v8
    global_load_dwordx4 v[30:33], v3, s[12:13]
K_NOWCL:
    v_mov_b32 v3, 2623488
    global_load_dword v127, v3, s[24:25]
    v_mov_b64 v[104:105], 0
    v_mov_b64 v[106:107], 0
    v_mov_b32 v6, 0
    v_mov_b32 v7, 0
    v_lshlrev_b32 v4, 4, v0
    ds_write_b128 v4, v[104:107]
    ds_write_b128 v4, v[104:107] offset:16384
    v_lshlrev_b32 v5, 3, v0
    ds_write_b64 v5, v[104:105] offset:32768
    v_mov_b32 v92, 1048512
    v_mov_b32 v93, 1048512
    v_mov_b64 v[94:95], v[92:93]
    v_mov_b32 v96, 134217727
    v_mov_b32 v97, 134217727
    v_mov_b64 v[98:99], v[96:97]
    v_lshlrev_b32 v4, 4, v0
    v_add_u32 v4, 61952, v4
    v_mov_b32 v100, 0
    v_lshlrev_b32 v5, 2, v1
    ds_write_b128 v4, v[92:95]
    ds_write_b128 v4, v[96:99] offset:16384
    ds_write2st64_b32 v5, v100, v100 offset0:240 offset1:241
    s_mov_b32 s40, s24
    s_and_b32 s41, s25, 0xffff
    s_mov_b32 s42, 6250496
    s_mov_b32 s43, 0x20000
    s_mov_b32 s36, s6
    s_or_b32 s37, s7, 524288
    s_mov_b32 s38, 640000
    s_mov_b32 s39, 0x20000
    s_lshl_b32 s90, s78, 10
    s_add_u32 m0, s90, 133792
    v_add_u32 v14, 16384, v2
    v_and_b32 v3, 0x30, v0
    v_and_b32 v4, 0x80, v0
    v_lshl_or_b32 v3, v3, 1, v4
    v_xor_b32 v14, v14, v3
    v_and_b32 v3, 15, v1
    s_and_b32 s90, s78, 7
    s_lshl_b32 s50, s90, 5
    v_lshl_add_u32 v15, v3, 1, s50
    v_lshrrev_b32 v3, 1, v0
    v_and_b32 v16, 0x78, v3
    s_cmp_ge_u32 s78, 10
    s_cbranch_scc1 K_PROLE
    v_add_u32 v18, 104096, v2
    v_lshlrev_b32 v19, 2, v0
    v_add_u32 v19, 114336, v19
    s_mul_i32 s51, s2, 10240
    s_lshl_b32 s52, s2, 12
    s_add_u32 s52, s52, 2641920
    v_lshlrev_b32 v48, 22, v0
    v_add_u32 v49, 1048576, v48
    v_add_u32 v50, 2097152, v48
    v_add_u32 v51, 3145728, v48
    v_mov_b32 v5, 4
    s_mov_b32 s89, 114336
    v_cmp_gt_u32 vcc, 625, v0
    s_waitcnt lgkmcnt(0)
    s_mov_b64 s[56:57], vcc
    s_barrier
    s_mov_b64 exec, s[56:57]
    s_waitcnt vmcnt(3)
    v_and_b32 v68, 255, v60
    v_lshl_add_u32 v68, v68, 2, s89
    ds_add_rtn_u32 v72, v68, v5
    v_and_b32 v69, 255, v61
    v_lshl_add_u32 v69, v69, 2, s89
    ds_add_rtn_u32 v73, v69, v5
    v_and_b32 v70, 255, v62
    v_lshl_add_u32 v70, v70, 2, s89
    ds_add_rtn_u32 v74, v70, v5
    v_and_b32 v71, 255, v63
    v_lshl_add_u32 v71, v71, 2, s89
    ds_add_rtn_u32 v75, v71, v5
    v_lshrrev_b32 v60, 8, v60
    v_or_b32 v48, v48, v60
    v_lshrrev_b32 v61, 8, v61
    v_or_b32 v49, v49, v61
    v_lshrrev_b32 v62, 8, v62
    v_or_b32 v50, v50, v62
    v_lshrrev_b32 v63, 8, v63
    v_or_b32 v51, v51, v63
    s_mov_b64 exec, -1
    s_waitcnt vmcnt(2) lgkmcnt(0)
    s_barrier
    ds_read_b128 v[76:79], v17
    s_waitcnt lgkmcnt(0)
    v_add_u32 v61, v76, v77
    v_add_u32 v62, v61, v78
    v_add_u32 v63, v62, v79
    v_mov_b32 v3, v63
    s_nop 1
    v_add_u32_dpp v3, v3, v3 row_shr:1 row_mask:0xf bank_mask:0xf bound_ctrl:0
    s_nop 1
    v_add_u32_dpp v3, v3, v3 row_shr:2 row_mask:0xf bank_mask:0xf bound_ctrl:0
    s_nop 1
    v_add_u32_dpp v3, v3, v3 row_shr:4 row_mask:0xf bank_mask:0xf bound_ctrl:0
    s_nop 1
    v_add_u32_dpp v3, v3, v3 row_shr:8 row_mask:0xf bank_mask:0xf bound_ctrl:0
    s_nop 1
    v_add_u32_dpp v3, v3, v3 row_bcast:15 row_mask:0xa bank_mask:0xf
    s_nop 1
    v_add_u32_dpp v3, v3, v3 row_bcast:31 row_mask:0xc bank_mask:0xf
    s_nop 1
    v_sub_u32 v80, v3, v63
    v_add_u32 v81, v80, v76
    v_add_u32 v82, v80, v61
    v_add_u32 v83, v80, v62
    ds_write_b128 v17, v[80:83] offset:1024
    s_mov_b64 exec, s[56:57]
    s_mov_b32 s89, 104096
    ds_read_b32 v60, v68 offset:1024
    ds_read_b32 v61, v69 offset:1024
    ds_read_b32 v62, v70 offset:1024
    ds_read_b32 v63, v71 offset:1024
    s_waitcnt vmcnt(0)
    v_readfirstlane_b32 s91, v127
    v_lshl_add_u32 v48, v64, 6, v48
    v_lshl_add_u32 v49, v65, 6, v49
    v_lshl_add_u32 v50, v66, 6, v50
    v_lshl_add_u32 v51, v67, 6, v51
    s_mul_i32 s1, s91, 0x9e3779b1
    s_add_u32 s1, s1, 0x7f4a7c15
    s_cmp_eq_u32 s1, s91
    s_addc_u32 s91, s1, 0
    s_mov_b32 s1, 0x200000
    v_add_u32 v48, s91, v48
    v_add_u32 v49, s91, v49
    v_add_u32 v50, s91, v50
    v_add_u32 v51, s91, v51
    s_waitcnt lgkmcnt(3)
    v_add3_u32 v60, v60, v72, s89
    ds_write_b32 v60, v48
    s_waitcnt lgkmcnt(3)
    v_add3_u32 v61, v61, v73, s89
    ds_write_b32 v61, v49
    s_waitcnt lgkmcnt(3)
    v_add3_u32 v62, v62, v74, s89
    ds_write_b32 v62, v50
    s_waitcnt lgkmcnt(3)
    v_add3_u32 v63, v63, v75, s89
    ds_write_b32 v63, v51
    ds_add_u32 v68, v48 offset:2048
    ds_add_u32 v69, v49 offset:2048
    ds_add_u32 v70, v50 offset:2048
    ds_add_u32 v71, v51 offset:2048
    s_mov_b64 exec, -1
    global_load_lds_dwordx4 v14, s[12:13]
    global_load_ushort v34, v15, s[14:15]
    global_load_dwordx2 v[38:39], v16, s[18:19]
    v_mov_b32 v77, s91
    v_mov_b32 v79, s91
    s_cmp_ge_u32 s78, 4
    s_waitcnt lgkmcnt(0)
    s_barrier
    ds_read_b128 v[60:63], v18
    s_cbranch_scc1 K_NOTABR
    ds_read2st64_b32 v[80:81], v19 offset0:0 offset1:4
    ds_read_b32 v78, v19 offset:2048
K_NOTABR:
    s_waitcnt lgkmcnt(0)
    buffer_store_dwordx4 v[60:63], v2, s[40:43], s51 offen sc1
    s_cbranch_scc1 K_AJOIN
    v_lshl_or_b32 v76, v80, 16, v81
    buffer_store_dwordx4 v[76:79], v2, s[40:43], s52 offen sc1
    s_branch K_AJOIN
K_PROLE:
    s_waitcnt lgkmcnt(0)
    s_barrier
    v_and_b32 v3, 31, v1
    v_lshrrev_b32 v4, 5, v1
    s_sub_u32 s90, s78, 10
    s_lshl_b32 s89, s90, 6
    s_add_u32 s89, s89, 117408
    v_bfe_u32 v40, v1, 2, 2
    v_xor_b32 v46, s90, v40
    s_mov_b32 s89, 117408
    v_lshl_add_u32 v40, v4, 3, v40
    v_lshlrev_b32 v40, 8, v40
    v_and_b32 v5, 1, v1
    v_lshl_add_u32 v40, v5, 5, v40
    v_and_b32 v5, 16, v1
    v_add3_u32 v40, v40, v5, s89
    v_and_b32 v5, 2, v1
    v_lshl_add_u32 v40, v5, 2, v40
    v_lshl_add_u32 v40, v46, 6, v40
    v_lshrrev_b32 v5, 3, v3
    v_lshlrev_b32 v41, 7, v3
    v_lshl_add_u32 v41, v5, 4, v41
    v_add_u32 v41, 94736, v41
    v_bfe_u32 v5, v1, 1, 3
    v_xor_b32 v5, v5, v4
    v_xor_b32 v48, 0, v5
    v_lshl_add_u32 v48, v48, 4, v41
    v_xor_b32 v49, 2, v5
    v_lshl_add_u32 v49, v49, 4, v41
    v_xor_b32 v50, 4, v5
    v_lshl_add_u32 v50, v50, 4, v41
    v_xor_b32 v51, 6, v5
    v_lshl_add_u32 v51, v51, 4, v41
    v_mul_u32_u24 v41, 272, v3
    v_lshl_add_u32 v41, v4, 5, v41
    s_lshl_b32 s89, s90, 6
    v_add_u32 v41, s89, v41
    v_subrev_u32 v3, 640, v0
    v_lshrrev_b32 v4, 4, v3
    v_and_b32 v5, 0xf0, v8
    v_mul_u32_u24 v42, 272, v4
    v_add_u32 v42, v42, v5
    v_and_b32 v5, 0x70, v8
    v_lshl_add_u32 v43, v4, 15, v5
    s_lshl_b32 s89, s76, 7
    v_add_u32 v43, s89, v43
    v_add_u32 v44, 786432, v43
    v_bfe_u32 v5, v1, 3, 1
    v_mul_u32_u24 v5, 1280000, v5
    v_add_u32 v5, 3690496, v5
    v_cmp_gt_u32 vcc, 1280000, v44
    v_add_u32 v43, v43, v5
    v_add_u32 v44, v44, v5
    s_mov_b32 s26, 3216550459
    s_mov_b32 s27, 3216550459
    s_mov_b64 s[56:57], vcc
    s_waitcnt vmcnt(1)
K_EP0D:
    s_barrier
    global_load_lds_dwordx4 v14, s[12:13]
    global_load_ushort v34, v15, s[14:15]
    global_load_dwordx2 v[38:39], v16, s[18:19]
    s_cmp_ge_u32 s78, 14
    s_cbranch_scc1 K_PWC
    ds_read_b128 v[76:79], v48
    ds_read_b64_tr_b16 v[60:61], v40 offset:0
    ds_read_b64_tr_b16 v[62:63], v40 offset:1024
    ds_read_b128 v[80:83], v49
    ds_read_b64_tr_b16 v[64:65], v40 offset:4096
    ds_read_b64_tr_b16 v[66:67], v40 offset:5120
    ds_read_b128 v[84:87], v50
    ds_read_b64_tr_b16 v[68:69], v40 offset:8192
    ds_read_b64_tr_b16 v[70:71], v40 offset:9216
    ds_read_b128 v[88:91], v51
    ds_read_b64_tr_b16 v[72:73], v40 offset:12288
    ds_read_b64_tr_b16 v[74:75], v40 offset:13312
    ds_read_b128 v[92:95], v48 offset:4160
    ds_read_b128 v[96:99], v49 offset:4160
    ds_read_b128 v[100:103], v50 offset:4160
    ds_read_b128 v[104:107], v51 offset:4160
    s_waitcnt lgkmcnt(13)
    v_mfma_f32_32x32x16_bf16 v[108:123], v[60:63], v[76:79], 0
    s_waitcnt lgkmcnt(10)
    v_mfma_f32_32x32x16_bf16 v[108:123], v[64:67], v[80:83], v[108:123]
    s_waitcnt lgkmcnt(7)
    v_mfma_f32_32x32x16_bf16 v[108:123], v[68:71], v[84:87], v[108:123]
    s_waitcnt lgkmcnt(4)
    v_mfma_f32_32x32x16_bf16 v[108:123], v[72:75], v[88:91], v[108:123]
    s_waitcnt lgkmcnt(3)
    v_mfma_f32_32x32x16_bf16 v[76:91], v[60:63], v[92:95], 0
    s_waitcnt lgkmcnt(2)
    v_mfma_f32_32x32x16_bf16 v[76:91], v[64:67], v[96:99], v[76:91]
    s_waitcnt lgkmcnt(1)
    v_mfma_f32_32x32x16_bf16 v[76:91], v[68:71], v[100:103], v[76:91]
    s_waitcnt lgkmcnt(0)
    v_mfma_f32_32x32x16_bf16 v[76:91], v[72:75], v[104:107], v[76:91]
    s_nop 3
    v_mul_f32 v108, s26, v108
    v_mul_f32 v109, s26, v109
    v_mul_f32 v110, s26, v110
    v_mul_f32 v111, s26, v111
    v_mul_f32 v112, s26, v112
    v_mul_f32 v113, s26, v113
    v_mul_f32 v114, s26, v114
    v_mul_f32 v115, s26, v115
    v_mul_f32 v116, s26, v116
    v_mul_f32 v117, s26, v117
    v_mul_f32 v118, s26, v118
    v_mul_f32 v119, s26, v119
    v_mul_f32 v120, s26, v120
    v_mul_f32 v121, s26, v121
    v_mul_f32 v122, s26, v122
    v_mul_f32 v123, s26, v123
    v_cvt_pk_bf16_f32 v108, v108, v109
    v_cvt_pk_bf16_f32 v109, v110, v111
    v_cvt_pk_bf16_f32 v110, v112, v113
    v_cvt_pk_bf16_f32 v111, v114, v115
    v_cvt_pk_bf16_f32 v112, v116, v117
    v_cvt_pk_bf16_f32 v113, v118, v119
    v_cvt_pk_bf16_f32 v114, v120, v121
    v_cvt_pk_bf16_f32 v115, v122, v123
    ds_write_b128 v41, v[108:111] offset:40960
    ds_write_b128 v41, v[112:115] offset:40976
    v_pk_mul_f32 v[76:77], v[76:77], s[26:27]
    v_pk_mul_f32 v[78:79], v[78:79], s[26:27]
    v_pk_mul_f32 v[80:81], v[80:81], s[26:27]
    v_pk_mul_f32 v[82:83], v[82:83], s[26:27]
    v_pk_mul_f32 v[84:85], v[84:85], s[26:27]
    v_pk_mul_f32 v[86:87], v[86:87], s[26:27]
    v_pk_mul_f32 v[88:89], v[88:89], s[26:27]
    v_pk_mul_f32 v[90:91], v[90:91], s[26:27]
    v_cvt_pk_bf16_f32 v76, v76, v77
    v_cvt_pk_bf16_f32 v77, v78, v79
    v_cvt_pk_bf16_f32 v78, v80, v81
    v_cvt_pk_bf16_f32 v79, v82, v83
    v_cvt_pk_bf16_f32 v80, v84, v85
    v_cvt_pk_bf16_f32 v81, v86, v87
    v_cvt_pk_bf16_f32 v82, v88, v89
    v_cvt_pk_bf16_f32 v83, v90, v91
    ds_write_b128 v41, v[76:79] offset:49664
    ds_write_b128 v41, v[80:83] offset:49680
    s_branch K_PB3
K_PWC:
    s_getpc_b64 s[58:59]
K_PC:
    s_add_u32 s58, s58, K_TABLE-K_PC
    s_addc_u32 s59, s59, 0
    s_and_b32 s89, s78, 1
    s_mul_i32 s90, s89, 2080
    s_add_u32 m0, s90, 99936
    s_lshl_b32 s89, s89, 11
    v_add_u32 v3, s89, v8
    global_load_lds_dwordx4 v3, s[58:59]
    s_add_u32 m0, m0, 16
    s_nop 0
    global_load_lds_dwordx4 v3, s[58:59] offset:1024
    s_cmp_eq_u32 s78, 14
    s_cbranch_scc1 K_EPF
    v_lshrrev_b32 v3, 4, v1
    v_mul_u32_u24 v3, 320, v3
    v_and_b32 v4, 0xf0, v8
    v_add_u32 v3, v3, v4
    v_add_u32 v3, 150176, v3
    v_lshlrev_b32 v60, 16, v30
    v_and_b32 v61, 0xffff0000, v30
    v_lshlrev_b32 v62, 16, v31
    v_and_b32 v63, 0xffff0000, v31
    v_lshlrev_b32 v64, 16, v32
    v_and_b32 v65, 0xffff0000, v32
    v_lshlrev_b32 v66, 16, v33
    v_and_b32 v67, 0xffff0000, v33
    v_pk_mul_f32 v[60:61], v[60:61], s[26:27]
    v_pk_mul_f32 v[62:63], v[62:63], s[26:27]
    v_pk_mul_f32 v[64:65], v[64:65], s[26:27]
    v_pk_mul_f32 v[66:67], v[66:67], s[26:27]
    v_and_b32 v68, 0xffff0000, v60
    v_and_b32 v69, 0xffff0000, v61
    v_and_b32 v70, 0xffff0000, v62
    v_and_b32 v71, 0xffff0000, v63
    v_and_b32 v72, 0xffff0000, v64
    v_and_b32 v73, 0xffff0000, v65
    v_and_b32 v74, 0xffff0000, v66
    v_and_b32 v75, 0xffff0000, v67
    v_sub_f32 v60, v60, v68
    v_sub_f32 v61, v61, v69
    v_sub_f32 v62, v62, v70
    v_sub_f32 v63, v63, v71
    v_sub_f32 v64, v64, v72
    v_sub_f32 v65, v65, v73
    v_sub_f32 v66, v66, v74
    v_sub_f32 v67, v67, v75
    v_cvt_pk_bf16_f32 v76, v68, v69
    v_cvt_pk_bf16_f32 v80, v60, v61
    v_cvt_pk_bf16_f32 v77, v70, v71
    v_cvt_pk_bf16_f32 v81, v62, v63
    v_cvt_pk_bf16_f32 v78, v72, v73
    v_cvt_pk_bf16_f32 v82, v64, v65
    v_cvt_pk_bf16_f32 v79, v74, v75
    v_cvt_pk_bf16_f32 v83, v66, v67
    ds_write_b128 v3, v[76:79]
    ds_write_b128 v3, v[80:83] offset:2560
    s_branch K_PB3
K_EPF:
    s_lshr_b32 s89, s2, 3
    s_mul_i32 s89, s89, 3072
    v_add_u32 v3, s89, v8
    buffer_load_dword v13, v3, s[36:39], 0 idxen
    v_add_u32 v3, 1024, v3
    buffer_load_dword v13, v3, s[36:39], 0 idxen
    v_add_u32 v3, 1024, v3
    buffer_load_dword v13, v3, s[36:39], 0 idxen
    v_add_u32 v3, 1024, v3
K_PB3:
    s_waitcnt lgkmcnt(0)
    s_barrier
    ds_read_b128 v[76:79], v42 offset:40960
    ds_read_b128 v[80:83], v42 offset:47488
    s_waitcnt lgkmcnt(1)
    buffer_store_dwordx4 v[76:79], v43, s[40:43], 0 offen sc1
    s_cmp_ge_u32 s78, 14
    s_cbranch_scc1 K_PSD
    s_mov_b64 exec, s[56:57]
    s_waitcnt lgkmcnt(0)
    buffer_store_dwordx4 v[80:83], v44, s[40:43], 0 offen sc1
    s_mov_b64 exec, -1
K_PSD:
K_AJOIN:
    v_lshrrev_b32 v9, 2, v0
    s_lshl_b32 s90, s76, 4
    s_add_u32 s90, s90, 2641920
    v_lshl_add_u32 v126, v9, 12, s90
    v_and_b32 v57, 48, v8
    v_mul_u32_u24 v56, 10240, v9
    v_add_u32 v56, v56, v57
    v_mul_u32_u24 v9, 2500, v9
    s_add_u32 s28, s24, 3687376
    s_addc_u32 s29, s25, 131072
    s_mov_b32 s30, 640000
    s_mov_b32 s31, 0x20000
    s_add_u32 s32, s24, 4967376
    s_addc_u32 s33, s25, 131072
    s_mov_b32 s34, 640000
    s_mov_b32 s35, 0x20000
    s_movk_i32 s79, 3120
    s_movk_i32 s80, 2080
    s_movk_i32 s81, 1040
    s_mov_b32 s82, 0xfffc0
    s_mov_b32 s87, 0
    s_mov_b32 s86, 0
    s_mul_i32 s0, s78, 4160
    s_add_u32 s0, s0, 94736
    v_lshrrev_b32 v4, 5, v1
    v_bfe_u32 v5, v1, 2, 2
    v_lshl_add_u32 v4, v4, 3, v5
    v_mul_u32_u24 v4, 320, v4
    v_and_b32 v5, 16, v1
    v_lshl_add_u32 v4, v5, 1, v4
    v_and_b32 v5, 3, v1
    v_lshl_add_u32 v4, v5, 3, v4
    v_add_u32 v58, 150176, v4
    v_add_u32 v59, 99936, v8
    s_lshr_b32 s89, s78, 3
    s_mul_i32 s48, s89, 2080
    s_lshl_b32 s89, s89, 13
    s_lshl_b32 s90, s50, 1
    s_add_u32 s49, s89, s90
    s_mov_b32 m0, s0
    s_cmp_lt_u32 s78, 4
    s_cbranch_scc1 K_J2
    s_sub_u32 s27, s78, 10
    s_cmp_lt_u32 s27, 4
    s_cbranch_scc1 K_J2
    s_waitcnt vmcnt(1)
K_J2:
    s_waitcnt vmcnt(2) lgkmcnt(0)
    s_barrier
    s_cmp_lt_u32 s78, 10
    s_cbranch_scc1 K_TAGD
    v_readfirstlane_b32 s91, v127
    s_nop 0
    s_mul_i32 s1, s91, 0x9e3779b1
    s_add_u32 s1, s1, 0x7f4a7c15
    s_cmp_eq_u32 s1, s91
    s_addc_u32 s91, s1, 0
    s_mov_b32 s1, 0x200000
K_TAGD:
    ds_read_b128 v[14:17], v59 offset:0
    ds_read_b128 v[18:21], v59 offset:1040
    ds_read_b128 v[22:25], v59 offset:2080
    ds_read_b128 v[26:29], v59 offset:3120
    ds_read_b64_tr_b16 v[60:61], v58 offset:0
    ds_read_b64_tr_b16 v[64:65], v58 offset:64
    ds_read_b64_tr_b16 v[68:69], v58 offset:128
    ds_read_b64_tr_b16 v[72:73], v58 offset:192
    s_cmp_ge_u32 s78, 8
    s_cbranch_scc1 K_QSK
    s_waitcnt lgkmcnt(7)
    v_xor_b32 v16, s50, v16
    v_add_u32 v16, 133792, v16
    ds_read_b128 v[116:119], v14
    ds_read_b128 v[120:123], v15
    ds_read_b64_tr_b16 v[108:109], v16 offset:0
    ds_read_b64_tr_b16 v[110:111], v16 offset:1024
    ds_read_b64_tr_b16 v[112:113], v16 offset:8192
    ds_read_b64_tr_b16 v[114:115], v16 offset:9216
    ds_read_b128 v[92:95], v14 offset:2080
    ds_read_b128 v[96:99], v15 offset:2080
    ds_read_b128 v[48:51], v14 offset:4160
    ds_read_b128 v[52:55], v15 offset:4160
    v_add_u32 v36, s49, v17
    s_mov_b32 s89, 3216550459
    v_lshlrev_b32 v34, 16, v34
    v_mul_f32 v34, s89, v34
    s_waitcnt lgkmcnt(4)
    v_mfma_f32_16x16x32_bf16 v[40:43], v[116:119], v[108:111], 0
    v_mfma_f32_16x16x32_bf16 v[40:43], v[120:123], v[112:115], v[40:43]
    s_waitcnt lgkmcnt(2)
    v_mfma_f32_16x16x32_bf16 v[100:103], v[92:95], v[108:111], 0
    v_mfma_f32_16x16x32_bf16 v[100:103], v[96:99], v[112:115], v[100:103]
    s_waitcnt lgkmcnt(0)
    v_mfma_f32_16x16x32_bf16 v[44:47], v[48:51], v[108:111], 0
    v_mfma_f32_16x16x32_bf16 v[44:47], v[52:55], v[112:115], v[44:47]
    s_nop 1
    v_fma_f32 v40, v40, s89, v34
    v_fma_f32 v41, v41, s89, v34
    v_fma_f32 v42, v42, s89, v34
    v_fma_f32 v43, v43, s89, v34
    v_and_b32 v116, 0xffff0000, v40
    v_and_b32 v117, 0xffff0000, v41
    v_and_b32 v118, 0xffff0000, v42
    v_and_b32 v119, 0xffff0000, v43
    v_sub_f32 v40, v40, v116
    v_sub_f32 v41, v41, v117
    v_sub_f32 v42, v42, v118
    v_sub_f32 v43, v43, v119
    v_cvt_pk_bf16_f32 v40, v116, v40
    v_cvt_pk_bf16_f32 v41, v117, v41
    v_cvt_pk_bf16_f32 v42, v118, v42
    v_cvt_pk_bf16_f32 v43, v119, v43
    ds_write2st64_b32 v36, v40, v41 offset0:0 offset1:2
    ds_write2st64_b32 v36, v42, v43 offset0:4 offset1:6
    v_fma_f32 v100, v100, s89, v34
    v_fma_f32 v101, v101, s89, v34
    v_fma_f32 v102, v102, s89, v34
    v_fma_f32 v103, v103, s89, v34
    v_and_b32 v116, 0xffff0000, v100
    v_and_b32 v117, 0xffff0000, v101
    v_and_b32 v118, 0xffff0000, v102
    v_and_b32 v119, 0xffff0000, v103
    v_sub_f32 v100, v100, v116
    v_sub_f32 v101, v101, v117
    v_sub_f32 v102, v102, v118
    v_sub_f32 v103, v103, v119
    v_cvt_pk_bf16_f32 v100, v116, v100
    v_cvt_pk_bf16_f32 v101, v117, v101
    v_cvt_pk_bf16_f32 v102, v118, v102
    v_cvt_pk_bf16_f32 v103, v119, v103
    ds_write2st64_b32 v36, v100, v101 offset0:32 offset1:34
    ds_write2st64_b32 v36, v102, v103 offset0:36 offset1:38
    s_cmp_ge_u32 s78, 8
    s_cbranch_scc1 K_QD
    s_mov_b32 exec_hi, 0
    v_fma_f32 v44, v44, s89, v34
    v_fma_f32 v45, v45, s89, v34
    v_fma_f32 v46, v46, s89, v34
    v_fma_f32 v47, v47, s89, v34
    v_and_b32 v116, 0xffff0000, v44
    v_and_b32 v117, 0xffff0000, v45
    v_and_b32 v118, 0xffff0000, v46
    v_and_b32 v119, 0xffff0000, v47
    v_sub_f32 v44, v44, v116
    v_sub_f32 v45, v45, v117
    v_sub_f32 v46, v46, v118
    v_sub_f32 v47, v47, v119
    v_cvt_pk_bf16_f32 v44, v116, v44
    v_cvt_pk_bf16_f32 v45, v117, v45
    v_cvt_pk_bf16_f32 v46, v118, v46
    v_cvt_pk_bf16_f32 v47, v119, v47
    ds_write2st64_b32 v36, v44, v45 offset0:64 offset1:66
    ds_write2st64_b32 v36, v46, v47 offset0:68 offset1:70
    s_mov_b32 exec_hi, -1
K_QSK:
    s_waitcnt lgkmcnt(4)
    v_add_u32 v26, s0, v26
    v_add_u32 v27, s0, v27
    v_add_u32 v28, s0, v28
    v_add_u32 v29, s0, v29
K_QD:
    s_cmp_lt_u32 s78, 10
    s_cbranch_scc1 K_POLL1A
    s_mov_b64 exec, 1
    v_mov_b32 v4, 61704
    v_mov_b32 v5, 1
    s_waitcnt vmcnt(0)
    ds_add_rtn_u32 v4, v4, v5
    s_mov_b64 exec, -1
    buffer_load_dwordx3 v[10:12], v126, s[40:43], 0 offen sc1
    v_mov_b32 v5, s91
    v_lshlrev_b32 v30, 2, v1
    s_lshl_b32 s26, s2, 6
    s_add_u32 s26, s26, 2625536
    s_waitcnt lgkmcnt(0)
    v_readfirstlane_b32 s90, v4
    s_cmp_lg_u32 s90, 5
    s_cbranch_scc1 K_POLL2A
    s_mov_b64 exec, 0xffff
    buffer_store_dword v5, v30, s[40:43], s26 offen sc1
    s_mov_b64 exec, -1
    s_waitcnt vmcnt(1)
    s_branch K_POLL3A
K_POLLA:
    s_mov_b64 exec, vcc
K_POLL1A:
    buffer_load_dwordx3 v[10:12], v126, s[40:43], 0 offen sc1
    s_sub_u32 s1, s1, 1
    s_cbranch_scc1 K_END
K_POLL2A:
    s_waitcnt vmcnt(0)
K_POLL3A:
    v_cmp_ne_u32 vcc, s91, v11
    s_cbranch_vccnz K_POLLA
    s_mov_b64 exec, -1
    v_add_u32_sdwa v56, v56, v10 dst_sel:DWORD dst_unused:UNUSED_PAD src0_sel:DWORD src1_sel:WORD_0
    v_lshrrev_b32 v10, 16, v10
    buffer_load_dwordx4 v[76:79], v56, s[40:43], 0 offen sc1
    v_cmp_lt_u32 vcc, 64, v10
    v_sub_u32 v10, v10, v57
    s_cmp_lg_u64 vcc, 0
    s_cselect_b32 s77, 1, 0
    s_cbranch_scc0 K_NOHIA
    s_mov_b64 exec, vcc
    buffer_load_dwordx4 v[80:83], v56, s[40:43], 0 offen offset:64 sc1
    s_mov_b64 exec, -1
K_NOHIA:
    v_cmp_lt_i32 s[56:57], 0, v10
    v_cmp_lt_i32 s[58:59], 4, v10
    v_cmp_lt_i32 s[60:61], 8, v10
    v_cmp_lt_i32 s[62:63], 12, v10
    v_and_b32 v126, 0x3fc, v0
    v_lshlrev_b32 v126, 4, v126
    v_add_u32 v126, 2625536, v126
K_VERA:
    s_waitcnt vmcnt(0)
K_VER1A:
    v_cndmask_b32 v92, 0, v76, s[56:57]
    v_cndmask_b32 v93, 0, v77, s[58:59]
    v_cndmask_b32 v94, 0, v78, s[60:61]
    v_cndmask_b32 v95, 0, v79, s[62:63]
    v_add3_u32 v4, v92, v93, v94
    s_cmp_lg_u32 s77, 0
    v_add_u32 v4, v4, v95
    s_cbranch_scc1 K_VHIA
K_VHBA:
    s_nop 1
    v_add_u32_dpp v4, v4, v4 quad_perm:[1,0,3,2] row_mask:0xf bank_mask:0xf
    s_nop 1
    v_add_u32_dpp v4, v4, v4 quad_perm:[2,3,0,1] row_mask:0xf bank_mask:0xf
    v_cmp_ne_u32 vcc, v4, v12
    s_cbranch_vccnz K_VREA
K_VOKA:
    v_subrev_u32 v76, s91, v76
    v_subrev_u32 v77, s91, v77
    v_subrev_u32 v78, s91, v78
    v_subrev_u32 v79, s91, v79
K_PASS1:
    v_mov_b32 v5, 4
    v_lshlrev_b32_sdwa v92, 2, v76 dst_sel:BYTE_0 dst_unused:UNUSED_PAD src0_sel:DWORD src1_sel:DWORD
    v_lshlrev_b32_sdwa v93, 2, v77 dst_sel:BYTE_0 dst_unused:UNUSED_PAD src0_sel:DWORD src1_sel:DWORD
    v_lshlrev_b32_sdwa v94, 2, v78 dst_sel:BYTE_0 dst_unused:UNUSED_PAD src0_sel:DWORD src1_sel:DWORD
    v_lshlrev_b32_sdwa v95, 2, v79 dst_sel:BYTE_0 dst_unused:UNUSED_PAD src0_sel:DWORD src1_sel:DWORD
    s_mov_b64 exec, s[56:57]
    ds_add_rtn_u32 v84, v92, v5 offset:61440
    s_mov_b64 exec, s[58:59]
    ds_add_rtn_u32 v85, v93, v5 offset:61440
    s_mov_b64 exec, s[60:61]
    ds_add_rtn_u32 v86, v94, v5 offset:61440
    s_mov_b64 exec, s[62:63]
    ds_add_rtn_u32 v87, v95, v5 offset:61440
    s_mov_b64 exec, -1
    s_cmp_lg_u32 s77, 0
    s_cbranch_scc1 K_HI1
K_HB1:
    v_lshrrev_b32 v100, 20, v76
    v_add_u32 v100, v100, v9
    v_lshrrev_b32 v101, 20, v77
    v_add_u32 v101, v101, v9
    v_lshrrev_b32 v102, 20, v78
    v_add_u32 v102, v102, v9
    v_lshrrev_b32 v103, 20, v79
    v_add_u32 v103, v103, v9
    v_lshlrev_b32 v2, 2, v1
    v_mov_b32 v4, 61696
    s_waitcnt lgkmcnt(0)
    s_barrier
    ds_read_b32 v3, v2 offset:61440
    ds_read_b32 v4, v4
    buffer_load_dword v127, v126, s[40:43], 0 offen sc1
    s_waitcnt lgkmcnt(1)
    v_add_u32 v5, 31, v3
    v_and_b32 v5, -32, v5
    v_mov_b32 v2, v5
    s_nop 1
    v_add_u32_dpp v2, v2, v2 row_shr:1 row_mask:0xf bank_mask:0xf bound_ctrl:0
    s_nop 1
    v_add_u32_dpp v2, v2, v2 row_shr:2 row_mask:0xf bank_mask:0xf bound_ctrl:0
    s_nop 1
    v_add_u32_dpp v2, v2, v2 row_shr:4 row_mask:0xf bank_mask:0xf bound_ctrl:0
    s_nop 1
    v_add_u32_dpp v2, v2, v2 row_shr:8 row_mask:0xf bank_mask:0xf bound_ctrl:0
    s_nop 1
    v_add_u32_dpp v2, v2, v2 row_bcast:15 row_mask:0xa bank_mask:0xf
    s_nop 1
    v_add_u32_dpp v2, v2, v2 row_bcast:31 row_mask:0xc bank_mask:0xf
    s_nop 1
    v_readlane_b32 s27, v2, 63
    v_sub_u32 v2, v2, v5
    v_add_u32 v2, 61952, v2
    s_waitcnt lgkmcnt(0)
    s_cmp_eq_u32 s77, 0
    s_cbranch_scc1 K_NOHB
    ds_bpermute_b32 v96, v96, v2
    ds_bpermute_b32 v97, v97, v2
    ds_bpermute_b32 v98, v98, v2
    ds_bpermute_b32 v99, v99, v2
K_NOHB:
    ds_bpermute_b32 v92, v92, v2
    ds_bpermute_b32 v93, v93, v2
    ds_bpermute_b32 v94, v94, v2
    ds_bpermute_b32 v95, v95, v2
    v_readfirstlane_b32 s26, v4
    v_lshrrev_b32 v4, 4, v1
    s_cmp_gt_u32 s27, 15872
    s_cselect_b32 s89, 1, 0
    s_or_b32 s26, s26, s89
    s_cbranch_scc1 K_GOSLOW
    v_add_u32 v7, v7, v3
    s_add_u32 s27, s27, 127
    s_lshr_b32 s27, s27, 7
    s_add_u32 s84, s27, 15
    s_sub_u32 s84, s84, s78
    s_lshr_b32 s84, s84, 4
    s_lshr_b32 s89, s27, 4
    s_mul_i32 s89, s89, s78
    s_and_b32 s27, s27, 15
    s_min_u32 s27, s27, s78
    s_add_u32 s89, s89, s27
    s_lshl_b32 s89, s89, 7
    s_lshl_b32 s90, s84, 5
    s_waitcnt lgkmcnt(0)
    v_add_u32 v92, v92, v84
    v_add_u32 v93, v93, v85
    v_add_u32 v94, v94, v86
    v_add_u32 v95, v95, v87
    s_mov_b64 exec, s[56:57]
    ds_write2st64_b32 v92, v76, v100 offset0:0 offset1:64
    s_mov_b64 exec, s[58:59]
    ds_write2st64_b32 v93, v77, v101 offset0:0 offset1:64
    s_mov_b64 exec, s[60:61]
    ds_write2st64_b32 v94, v78, v102 offset0:0 offset1:64
    s_mov_b64 exec, s[62:63]
    ds_write2st64_b32 v95, v79, v103 offset0:0 offset1:64
    s_mov_b64 exec, -1
    s_cmp_lg_u32 s77, 0
    s_cbranch_scc1 K_HI2
K_HB2:
    s_cmp_lg_u32 s78, 15
    s_cbranch_scc1 K_NOGAP
    v_mul_u32_u24 v5, 1040, v1
    v_add_u32 v5, 94720, v5
    v_mov_b64 v[40:41], 0
    v_mov_b64 v[42:43], 0
    ds_write_b128 v5, v[40:43]
    ds_write_b128 v5, v[40:43] offset:1040
K_NOGAP:
    v_mul_u32_u24 v4, s90, v4
    v_add3_u32 v14, v4, v21, s89
    v_mul_u32_u24 v15, s90, v20
    v_add3_u32 v15, v15, v19, s89
    v_add3_u32 v17, v25, v4, s89
    s_waitcnt vmcnt(0)
K_PFC:
    v_cmp_ne_u32 vcc, s91, v127
    s_cbranch_vccnz K_PFR
    s_sub_u32 s26, s78, 0
    s_cmp_ge_u32 s26, 3
    s_cbranch_scc1 K_NOWO
    s_lshr_b32 s26, s2, 3
    s_mul_i32 s26, s26, 24576
    s_add_u32 s26, s26, 3690496
    v_lshlrev_b32 v40, 7, v0
    buffer_load_dword v13, v40, s[40:43], s26 offen sc1
    s_add_u32 s26, s26, 24576
K_NOWO:
K_PFD:
    s_waitcnt lgkmcnt(0)
    s_barrier
    ds_read_b128 v[30:33], v14
    ds_read_b32 v16, v15
    ds_read_b32 v17, v17
    s_waitcnt lgkmcnt(2)
    v_and_or_b32 v30, v30, s82, v24
    v_and_or_b32 v31, v31, s82, v24
    v_and_or_b32 v32, v32, s82, v24
    v_and_or_b32 v33, v33, s82, v24
    buffer_load_dwordx4 v30, s[28:31], s79 idxen offset:0 sc1 lds
    buffer_load_dwordx4 v31, s[28:31], s80 idxen offset:1040 sc1 lds
    buffer_load_dwordx4 v32, s[28:31], s81 idxen offset:2080 sc1 lds
    buffer_load_dwordx4 v33, s[28:31], 0 idxen offset:3120 sc1 lds
    s_waitcnt lgkmcnt(1)
    buffer_load_dwordx2 v[56:57], v16, s[36:39], 0 idxen
K_ED0:
    s_and_b32 s90, s78, 3
    s_lshl_b32 s90, s90, 5
    v_lshrrev_b32 v3, 4, v1
    v_lshl_add_u32 v11, v3, 3, s90
    s_xor_b32 s89, s78, 15
    s_or_b32 s89, s2, s89
    s_cbranch_scc1 K_EPD
    v_mov_b32 v2, 2623488
    v_mov_b32 v4, s91
    global_store_dword v2, v4, s[24:25]
K_EPD:
    s_waitcnt lgkmcnt(0)
    s_mov_b32 s85, 0
    s_mov_b32 s44, s20
    s_and_b32 s45, s21, 0xffff
    s_mov_b32 s46, 1280000
    s_mov_b32 s47, 0x20000
    v_mul_u32_u24 v9, 4160, v3
    v_bfe_u32 v2, v1, 2, 2
    v_lshl_add_u32 v9, v2, 7, v9
    v_and_b32 v2, 3, v1
    v_lshl_add_u32 v9, v2, 3, v9
    s_add_u32 s90, s90, 94736
    v_add_u32 v9, s90, v9
    v_and_b32 v2, 15, v1
    s_and_b32 s89, s78, 12
    s_lshl_b32 s89, s89, 2
    v_add_u32 v2, s89, v2
    v_mul_u32_u24 v10, 272, v2
    v_lshl_add_u32 v10, v3, 4, v10
    v_add_u32 v10, 61952, v10
    v_lshlrev_b32 v12, 2, v2
    ds_bpermute_b32 v12, v12, v7
    v_lshl_add_u32 v11, v2, 15, v11
    v_lshlrev_b32 v4, 4, v0
    s_mul_i32 s26, s78, 272
    s_add_u32 s26, s26, 61952
    v_lshl_add_u32 v5, v1, 2, s26
    s_cmp_eq_u32 s84, 0
    s_cbranch_scc1 K_DONE
    v_cmp_gt_u32 vcc, s38, v16
    v_and_b32 v17, 63, v17
    v_lshlrev_b32 v17, 9, v17
    v_cndmask_b32 v58, 0, v22, vcc
    v_cndmask_b32 v59, 0, v23, vcc
    v_mov_b32 v2, v17
    v_add_u32 v14, 32, v14
    v_add_u32 v15, 32, v15
    v_mov_b32_dpp v2, v17 row_shr:1 row_mask:0xf bank_mask:0xf
    v_mov_b32_dpp v34, v17 row_newbcast:0 row_mask:0xf bank_mask:0xf
    v_mov_b32_dpp v35, v17 row_newbcast:0 row_mask:0xf bank_mask:0xf
    v_mov_b64 v[48:49], 0
    v_mov_b64 v[50:51], 0
    v_permlane16_swap_b32 v34, v35
    v_mov_b64 v[52:53], 0
    v_mov_b64 v[54:55], 0
    v_add_u32 v34, v34, v18
    v_add_u32 v35, v35, v18
    ds_read_b32 v62, v34 offset:40960
    ds_read_b32 v63, v35 offset:40960
    ds_read_b32 v66, v34 offset:41088
    ds_read_b32 v67, v35 offset:41088
    ds_read_b32 v70, v34 offset:41216
    ds_read_b32 v71, v35 offset:41216
    ds_read_b32 v74, v34 offset:41344
    ds_read_b32 v75, v35 offset:41344
    v_lshlrev_b32 v36, 1, v34
    v_lshlrev_b32 v37, 1, v35
    v_cmp_ne_u32 vcc, v2, v17
    s_or_b32 s3, vcc_lo, vcc_hi
    s_lshr_b32 s89, s3, 16
    s_or_b32 s3, s3, s89
    s_setprio 3
    s_cmp_eq_u32 s87, 0
    s_cbranch_scc0 K_LOOP_S
.p2align 6
K_LOOP_F:
    s_waitcnt vmcnt(1)
    ds_read_b64_tr_b16 v[76:77], v26 offset:0
    ds_read_b64_tr_b16 v[78:79], v26 offset:1040
    ds_read_b64_tr_b16 v[80:81], v26 offset:2080
    ds_read_b64_tr_b16 v[82:83], v26 offset:3120
    ds_read_b64_tr_b16 v[84:85], v27 offset:0
    ds_read_b64_tr_b16 v[86:87], v27 offset:1040
    ds_read_b64_tr_b16 v[88:89], v27 offset:2080
    ds_read_b64_tr_b16 v[90:91], v27 offset:3120
    ds_read_b64_tr_b16 v[92:93], v28 offset:0
    ds_read_b64_tr_b16 v[94:95], v28 offset:1040
    ds_read_b64_tr_b16 v[96:97], v28 offset:2080
    ds_read_b64_tr_b16 v[98:99], v28 offset:3120
    ds_read_b64_tr_b16 v[100:101], v29 offset:0
    ds_read_b64_tr_b16 v[102:103], v29 offset:1040
    ds_read_b64_tr_b16 v[104:105], v29 offset:2080
    ds_read_b64_tr_b16 v[106:107], v29 offset:3120
    s_cmp_gt_u32 s84, 2
    s_cbranch_scc0 K_PRIO_F
K_PB_F:
    s_waitcnt vmcnt(0) lgkmcnt(8)
    v_mfma_f32_32x32x16_bf16 v[76:91], v[56:59], v[60:63], v[76:91]
    s_waitcnt lgkmcnt(0)
    v_mfma_f32_32x32x16_bf16 v[92:107], v[56:59], v[64:67], v[92:107]
    buffer_load_dwordx4 v30, s[32:35], s79 idxen offset:0 sc1 lds
    buffer_load_dwordx4 v31, s[32:35], s80 idxen offset:1040 sc1 lds
    buffer_load_dwordx4 v32, s[32:35], s81 idxen offset:2080 sc1 lds
    buffer_load_dwordx4 v33, s[32:35], 0 idxen offset:3120 sc1 lds
    ds_read_b128 v[30:33], v14
    ds_read_b32 v16, v15
    s_lshr_b32 s3, s3, 1
    s_sub_u32 s84, s84, 1
    s_nop 1
    v_exp_f32 v108, v76
    v_exp_f32 v109, v77
    v_exp_f32 v110, v78
    v_exp_f32 v111, v79
    v_exp_f32 v112, v80
    v_exp_f32 v113, v81
    v_exp_f32 v114, v82
    v_exp_f32 v115, v83
    v_exp_f32 v116, v84
    v_exp_f32 v117, v85
    v_exp_f32 v118, v86
    v_exp_f32 v119, v87
    v_exp_f32 v120, v88
    v_exp_f32 v121, v89
    v_exp_f32 v122, v90
    v_exp_f32 v123, v91
    v_mov_b32_dpp v17, v17 row_shl:1 row_mask:0xf bank_mask:0xf bound_ctrl:0
    v_pk_add_f32 v[124:125], v[108:109], 1.0 op_sel_hi:[1,0]
    v_pk_fma_f32 v[44:45], v[76:77], v[110:111], v[76:77]
    v_pk_fma_f32 v[2:3], v[78:79], v[124:125], v[44:45]
    v_pk_fma_f32 v[124:125], v[124:125], v[110:111], v[124:125]
    v_pk_fma_f32 v[44:45], v[2:3], v[112:113], v[2:3]
    v_pk_fma_f32 v[2:3], v[80:81], v[124:125], v[44:45]
    v_pk_fma_f32 v[124:125], v[124:125], v[112:113], v[124:125]
    v_pk_fma_f32 v[44:45], v[2:3], v[114:115], v[2:3]
    v_pk_fma_f32 v[2:3], v[82:83], v[124:125], v[44:45]
    v_pk_fma_f32 v[124:125], v[124:125], v[114:115], v[124:125]
    v_pk_fma_f32 v[44:45], v[2:3], v[116:117], v[2:3]
    v_pk_fma_f32 v[2:3], v[84:85], v[124:125], v[44:45]
    v_pk_fma_f32 v[124:125], v[124:125], v[116:117], v[124:125]
    v_pk_fma_f32 v[44:45], v[2:3], v[118:119], v[2:3]
    v_pk_fma_f32 v[2:3], v[86:87], v[124:125], v[44:45]
    v_pk_fma_f32 v[124:125], v[124:125], v[118:119], v[124:125]
    v_pk_fma_f32 v[44:45], v[2:3], v[120:121], v[2:3]
    v_pk_fma_f32 v[2:3], v[88:89], v[124:125], v[44:45]
    v_pk_fma_f32 v[124:125], v[124:125], v[120:121], v[124:125]
    v_pk_fma_f32 v[44:45], v[2:3], v[122:123], v[2:3]
    v_pk_fma_f32 v[2:3], v[90:91], v[124:125], v[44:45]
    v_pk_fma_f32 v[124:125], v[124:125], v[122:123], v[124:125]
    v_exp_f32 v108, v92
    v_exp_f32 v109, v93
    v_exp_f32 v110, v94
    v_exp_f32 v111, v95
    v_exp_f32 v112, v96
    v_exp_f32 v113, v97
    v_exp_f32 v114, v98
    v_exp_f32 v115, v99
    v_exp_f32 v116, v100
    v_exp_f32 v117, v101
    v_exp_f32 v118, v102
    v_exp_f32 v119, v103
    v_exp_f32 v120, v104
    v_exp_f32 v121, v105
    v_exp_f32 v122, v106
    v_exp_f32 v123, v107
    v_pk_add_f32 v[42:43], v[108:109], 1.0 op_sel_hi:[1,0]
    v_pk_fma_f32 v[44:45], v[92:93], v[110:111], v[92:93]
    v_pk_fma_f32 v[40:41], v[94:95], v[42:43], v[44:45]
    v_pk_fma_f32 v[42:43], v[42:43], v[110:111], v[42:43]
    v_pk_fma_f32 v[44:45], v[40:41], v[112:113], v[40:41]
    v_pk_fma_f32 v[40:41], v[96:97], v[42:43], v[44:45]
    v_pk_fma_f32 v[42:43], v[42:43], v[112:113], v[42:43]
    v_pk_fma_f32 v[44:45], v[40:41], v[114:115], v[40:41]
    v_pk_fma_f32 v[40:41], v[98:99], v[42:43], v[44:45]
    v_pk_fma_f32 v[42:43], v[42:43], v[114:115], v[42:43]
    v_pk_fma_f32 v[44:45], v[40:41], v[116:117], v[40:41]
    v_pk_fma_f32 v[40:41], v[100:101], v[42:43], v[44:45]
    v_pk_fma_f32 v[42:43], v[42:43], v[116:117], v[42:43]
    v_pk_fma_f32 v[44:45], v[40:41], v[118:119], v[40:41]
    v_pk_fma_f32 v[40:41], v[102:103], v[42:43], v[44:45]
    v_pk_fma_f32 v[42:43], v[42:43], v[118:119], v[42:43]
    v_pk_fma_f32 v[44:45], v[40:41], v[120:121], v[40:41]
    v_pk_fma_f32 v[40:41], v[104:105], v[42:43], v[44:45]
    v_pk_fma_f32 v[42:43], v[42:43], v[120:121], v[42:43]
    v_pk_fma_f32 v[44:45], v[40:41], v[122:123], v[40:41]
    v_pk_fma_f32 v[40:41], v[106:107], v[42:43], v[44:45]
    v_pk_fma_f32 v[42:43], v[42:43], v[122:123], v[42:43]
    v_pk_mul_f32 v[44:45], v[124:125], v[42:43]
    v_rcp_f32 v46, v44
    v_rcp_f32 v47, v45
    v_pk_mul_f32 v[2:3], v[2:3], v[42:43]
    v_pk_mul_f32 v[40:41], v[40:41], v[124:125]
    v_max3_f32 v6, v6, v44, v45
    v_pk_fma_f32 v[48:49], v[2:3], v[46:47], v[48:49]
    v_pk_fma_f32 v[50:51], v[40:41], v[46:47], v[50:51]
    s_waitcnt lgkmcnt(0)
    v_and_or_b32 v30, v30, s82, v24
    v_and_or_b32 v31, v31, s82, v24
    v_and_or_b32 v32, v32, s82, v24
    v_and_or_b32 v33, v33, s82, v24
    v_cmp_gt_u32 vcc, s38, v16
    s_waitcnt vmcnt(0)
    ds_read_b64_tr_b16 v[76:77], v26 offset:0
    ds_read_b64_tr_b16 v[78:79], v26 offset:1040
    ds_read_b64_tr_b16 v[80:81], v26 offset:2080
    ds_read_b64_tr_b16 v[82:83], v26 offset:3120
    ds_read_b64_tr_b16 v[84:85], v27 offset:0
    ds_read_b64_tr_b16 v[86:87], v27 offset:1040
    ds_read_b64_tr_b16 v[88:89], v27 offset:2080
    ds_read_b64_tr_b16 v[90:91], v27 offset:3120
    ds_read_b64_tr_b16 v[92:93], v28 offset:0
    ds_read_b64_tr_b16 v[94:95], v28 offset:1040
    ds_read_b64_tr_b16 v[96:97], v28 offset:2080
    ds_read_b64_tr_b16 v[98:99], v28 offset:3120
    ds_read_b64_tr_b16 v[100:101], v29 offset:0
    ds_read_b64_tr_b16 v[102:103], v29 offset:1040
    ds_read_b64_tr_b16 v[104:105], v29 offset:2080
    ds_read_b64_tr_b16 v[106:107], v29 offset:3120
    s_cmp_eq_u32 s84, 0
    s_waitcnt lgkmcnt(8)
    v_mfma_f32_32x32x16_bf16 v[76:91], v[56:59], v[68:71], v[76:91]
    s_waitcnt lgkmcnt(0)
    v_mfma_f32_32x32x16_bf16 v[92:107], v[56:59], v[72:75], v[92:107]
    s_cbranch_scc1 K_TL_F
    buffer_load_dwordx4 v30, s[28:31], s79 idxen offset:0 sc1 lds
    buffer_load_dwordx4 v31, s[28:31], s80 idxen offset:1040 sc1 lds
    buffer_load_dwordx4 v32, s[28:31], s81 idxen offset:2080 sc1 lds
    buffer_load_dwordx4 v33, s[28:31], 0 idxen offset:3120 sc1 lds
    buffer_load_dwordx2 v[56:57], v16, s[36:39], 0 idxen
    v_cndmask_b32 v58, 0, v22, vcc
    v_cndmask_b32 v59, 0, v23, vcc
    v_add_u32 v14, 32, v14
    v_add_u32 v15, 32, v15
K_TB_F:
    v_exp_f32 v108, v76
    v_exp_f32 v109, v77
    v_exp_f32 v110, v78
    v_exp_f32 v111, v79
    v_exp_f32 v112, v80
    v_exp_f32 v113, v81
    v_exp_f32 v114, v82
    v_exp_f32 v115, v83
    v_exp_f32 v116, v84
    v_exp_f32 v117, v85
    v_exp_f32 v118, v86
    v_exp_f32 v119, v87
    v_exp_f32 v120, v88
    v_exp_f32 v121, v89
    v_exp_f32 v122, v90
    v_exp_f32 v123, v91
    v_pk_add_f32 v[124:125], v[108:109], 1.0 op_sel_hi:[1,0]
    v_pk_fma_f32 v[44:45], v[76:77], v[110:111], v[76:77]
    v_pk_fma_f32 v[2:3], v[78:79], v[124:125], v[44:45]
    v_pk_fma_f32 v[124:125], v[124:125], v[110:111], v[124:125]
    v_pk_fma_f32 v[44:45], v[2:3], v[112:113], v[2:3]
    v_pk_fma_f32 v[2:3], v[80:81], v[124:125], v[44:45]
    v_pk_fma_f32 v[124:125], v[124:125], v[112:113], v[124:125]
    v_pk_fma_f32 v[44:45], v[2:3], v[114:115], v[2:3]
    v_pk_fma_f32 v[2:3], v[82:83], v[124:125], v[44:45]
    v_pk_fma_f32 v[124:125], v[124:125], v[114:115], v[124:125]
    v_pk_fma_f32 v[44:45], v[2:3], v[116:117], v[2:3]
    v_pk_fma_f32 v[2:3], v[84:85], v[124:125], v[44:45]
    v_pk_fma_f32 v[124:125], v[124:125], v[116:117], v[124:125]
    v_pk_fma_f32 v[44:45], v[2:3], v[118:119], v[2:3]
    v_pk_fma_f32 v[2:3], v[86:87], v[124:125], v[44:45]
    v_pk_fma_f32 v[124:125], v[124:125], v[118:119], v[124:125]
    v_pk_fma_f32 v[44:45], v[2:3], v[120:121], v[2:3]
    v_pk_fma_f32 v[2:3], v[88:89], v[124:125], v[44:45]
    v_pk_fma_f32 v[124:125], v[124:125], v[120:121], v[124:125]
    v_pk_fma_f32 v[44:45], v[2:3], v[122:123], v[2:3]
    v_pk_fma_f32 v[2:3], v[90:91], v[124:125], v[44:45]
    v_pk_fma_f32 v[124:125], v[124:125], v[122:123], v[124:125]
    v_exp_f32 v108, v92
    v_exp_f32 v109, v93
    v_exp_f32 v110, v94
    v_exp_f32 v111, v95
    v_exp_f32 v112, v96
    v_exp_f32 v113, v97
    v_exp_f32 v114, v98
    v_exp_f32 v115, v99
    v_exp_f32 v116, v100
    v_exp_f32 v117, v101
    v_exp_f32 v118, v102
    v_exp_f32 v119, v103
    v_exp_f32 v120, v104
    v_exp_f32 v121, v105
    v_exp_f32 v122, v106
    v_exp_f32 v123, v107
    v_pk_add_f32 v[42:43], v[108:109], 1.0 op_sel_hi:[1,0]
    v_pk_fma_f32 v[44:45], v[92:93], v[110:111], v[92:93]
    v_pk_fma_f32 v[40:41], v[94:95], v[42:43], v[44:45]
    v_pk_fma_f32 v[42:43], v[42:43], v[110:111], v[42:43]
    v_pk_fma_f32 v[44:45], v[40:41], v[112:113], v[40:41]
    v_pk_fma_f32 v[40:41], v[96:97], v[42:43], v[44:45]
    v_pk_fma_f32 v[42:43], v[42:43], v[112:113], v[42:43]
    v_pk_fma_f32 v[44:45], v[40:41], v[114:115], v[40:41]
    v_pk_fma_f32 v[40:41], v[98:99], v[42:43], v[44:45]
    v_pk_fma_f32 v[42:43], v[42:43], v[114:115], v[42:43]
    v_pk_fma_f32 v[44:45], v[40:41], v[116:117], v[40:41]
    v_pk_fma_f32 v[40:41], v[100:101], v[42:43], v[44:45]
    v_pk_fma_f32 v[42:43], v[42:43], v[116:117], v[42:43]
    v_pk_fma_f32 v[44:45], v[40:41], v[118:119], v[40:41]
    v_pk_fma_f32 v[40:41], v[102:103], v[42:43], v[44:45]
    v_pk_fma_f32 v[42:43], v[42:43], v[118:119], v[42:43]
    v_pk_fma_f32 v[44:45], v[40:41], v[120:121], v[40:41]
    v_pk_fma_f32 v[40:41], v[104:105], v[42:43], v[44:45]
    v_pk_fma_f32 v[42:43], v[42:43], v[120:121], v[42:43]
    v_pk_fma_f32 v[44:45], v[40:41], v[122:123], v[40:41]
    v_pk_fma_f32 v[40:41], v[106:107], v[42:43], v[44:45]
    v_pk_fma_f32 v[42:43], v[42:43], v[122:123], v[42:43]
    v_pk_mul_f32 v[44:45], v[124:125], v[42:43]
    v_rcp_f32 v46, v44
    v_rcp_f32 v47, v45
    v_pk_mul_f32 v[2:3], v[2:3], v[42:43]
    v_pk_mul_f32 v[40:41], v[40:41], v[124:125]
    v_max3_f32 v6, v6, v44, v45
    v_pk_fma_f32 v[52:53], v[2:3], v[46:47], v[52:53]
    v_pk_fma_f32 v[54:55], v[40:41], v[46:47], v[54:55]
    s_cmp_eq_u32 s84, 0
    s_cbranch_scc1 K_LAST_F
    s_bitcmp1_b32 s3, 0
    s_cbranch_scc0 K_LOOP_F
    v_mov_b32_dpp v34, v17 row_newbcast:0 row_mask:0xf bank_mask:0xf
    v_mov_b32_dpp v35, v17 row_newbcast:0 row_mask:0xf bank_mask:0xf
    v_cvt_f64_f32 v[108:109], v48
    v_cvt_f64_f32 v[110:111], v49
    v_permlane16_swap_b32 v34, v35
    v_cvt_f64_f32 v[112:113], v50
    v_cvt_f64_f32 v[114:115], v51
    v_add_u32 v34, v34, v18
    v_add_u32 v35, v35, v18
    v_cvt_f64_f32 v[116:117], v52
    v_cvt_f64_f32 v[118:119], v53
    v_cvt_f64_f32 v[120:121], v54
    v_cvt_f64_f32 v[122:123], v55
    ds_read_b32 v62, v34 offset:40960
    ds_read_b32 v63, v35 offset:40960
    ds_read_b32 v66, v34 offset:41088
    ds_read_b32 v67, v35 offset:41088
    ds_read_b32 v70, v34 offset:41216
    ds_read_b32 v71, v35 offset:41216
    ds_read_b32 v74, v34 offset:41344
    ds_read_b32 v75, v35 offset:41344
    ds_add_f64 v36, v[108:109] offset:0
    ds_add_f64 v37, v[110:111] offset:0
    ds_add_f64 v36, v[112:113] offset:256
    ds_add_f64 v37, v[114:115] offset:256
    ds_add_f64 v36, v[116:117] offset:512
    ds_add_f64 v37, v[118:119] offset:512
    ds_add_f64 v36, v[120:121] offset:768
    ds_add_f64 v37, v[122:123] offset:768
    v_mov_b64 v[48:49], 0
    v_mov_b64 v[50:51], 0
    v_mov_b64 v[52:53], 0
    v_mov_b64 v[54:55], 0
    v_lshlrev_b32 v36, 1, v34
    v_lshlrev_b32 v37, 1, v35
    s_branch K_LOOP_F
K_PRIO_F:
    s_setprio 2
    s_cmp_gt_u32 s84, 1
    s_cbranch_scc1 K_PB_F
    s_setprio 1
    s_branch K_PB_F
K_TL_F:
    s_setprio 0
    global_load_lds_dwordx4 v4, s[16:17]
    s_mov_b32 s85, 1
    s_nop 5
    s_branch K_TB_F
K_LAST_F:
    v_cvt_f64_f32 v[108:109], v48
    v_cvt_f64_f32 v[110:111], v49
    v_cvt_f64_f32 v[112:113], v50
    v_cvt_f64_f32 v[114:115], v51
    v_cvt_f64_f32 v[116:117], v52
    v_cvt_f64_f32 v[118:119], v53
    v_cvt_f64_f32 v[120:121], v54
    v_cvt_f64_f32 v[122:123], v55
    ds_add_f64 v36, v[108:109] offset:0
    ds_add_f64 v37, v[110:111] offset:0
    ds_add_f64 v36, v[112:113] offset:256
    ds_add_f64 v37, v[114:115] offset:256
    ds_add_f64 v36, v[116:117] offset:512
    ds_add_f64 v37, v[118:119] offset:512
    ds_add_f64 v36, v[120:121] offset:768
    ds_add_f64 v37, v[122:123] offset:768
K_DONE:
    s_setprio 0
    s_cmp_eq_u32 s86, 0
    s_cbranch_scc0 K_NEXTCHUNK
K_FIN:
    s_cmp_lg_u32 s85, 0
    s_cbranch_scc1 K_W2D
    global_load_lds_dwordx4 v4, s[16:17]
K_W2D:
    s_waitcnt lgkmcnt(0)
    s_barrier
    ds_read_b128 v[76:79], v4 offset:0
    ds_read_b128 v[80:83], v4 offset:16384
    ds_read_b128 v[84:87], v4 offset:32768
    s_cmp_ge_u32 s78, 8
    v_add_u32 v36, 4352, v5
    v_add_u32 v37, 8704, v5
    s_waitcnt lgkmcnt(2)
    v_cvt_f32_f64 v108, v[76:77]
    v_cvt_f32_f64 v109, v[78:79]
    s_waitcnt lgkmcnt(1)
    v_cvt_f32_f64 v110, v[80:81]
    v_cvt_f32_f64 v111, v[82:83]
    v_and_b32 v116, 0xffff0000, v108
    v_and_b32 v117, 0xffff0000, v109
    v_and_b32 v118, 0xffff0000, v110
    v_and_b32 v119, 0xffff0000, v111
    v_pk_add_f32 v[108:109], v[108:109], v[116:117] neg_lo:[0,1] neg_hi:[0,1]
    v_pk_add_f32 v[110:111], v[110:111], v[118:119] neg_lo:[0,1] neg_hi:[0,1]
    v_cvt_pk_bf16_f32 v76, v116, v117
    v_cvt_pk_bf16_f32 v77, v108, v109
    v_cvt_pk_bf16_f32 v80, v118, v119
    v_cvt_pk_bf16_f32 v81, v110, v111
    ds_write2st64_b32 v5, v76, v77 offset0:0 offset1:64
    ds_write2st64_b32 v36, v80, v81 offset0:0 offset1:64
    v_add_f32 v108, v108, v109
    v_add_f32 v110, v110, v111
    v_cmp_u_f32 s[26:27], v108, v110
    s_cbranch_scc1 K_S1D
    s_waitcnt lgkmcnt(2)
    v_cvt_f32_f64 v112, v[84:85]
    v_cvt_f32_f64 v113, v[86:87]
    v_and_b32 v120, 0xffff0000, v112
    v_and_b32 v121, 0xffff0000, v113
    v_pk_add_f32 v[112:113], v[112:113], v[120:121] neg_lo:[0,1] neg_hi:[0,1]
    v_cvt_pk_bf16_f32 v84, v120, v121
    v_cvt_pk_bf16_f32 v85, v112, v113
    ds_write2st64_b32 v37, v84, v85 offset0:0 offset1:64
    v_cmp_u_f32 vcc, v112, v113
    s_or_b64 s[26:27], s[26:27], vcc
K_S1D:
    v_cmp_lt_f32 vcc, 2071986176, v6
    s_or_b64 vcc, vcc, s[26:27]
    v_mov_b32 v4, 61700
    s_cbranch_vccz K_NOFL
    ds_write_b32 v4, v4
K_NOFL:
    s_waitcnt vmcnt(0) lgkmcnt(0)
    s_barrier
    ds_read_b32 v4, v4
    s_cmp_ge_u32 s78, 12
    s_cbranch_scc1 K_IDLE
    ds_read_b64_tr_b16 v[92:93], v9 offset:0
    ds_read_b64_tr_b16 v[94:95], v9 offset:512
    ds_read_b64_tr_b16 v[96:97], v9 offset:16640
    ds_read_b64_tr_b16 v[98:99], v9 offset:17152
    ds_read_b64_tr_b16 v[100:101], v9 offset:33280
    ds_read_b64_tr_b16 v[102:103], v9 offset:33792
    ds_read_b64_tr_b16 v[104:105], v9 offset:49920
    ds_read_b64_tr_b16 v[106:107], v9 offset:50432
    ds_read_b128 v[76:79], v10 offset:0
    ds_read_b128 v[108:111], v10 offset:16384
    ds_read_b128 v[80:83], v10 offset:64
    ds_read_b128 v[112:115], v10 offset:16448
    ds_read_b128 v[84:87], v10 offset:128
    ds_read_b128 v[116:119], v10 offset:16512
    ds_read_b128 v[88:91], v10 offset:192
    ds_read_b128 v[120:123], v10 offset:16576
    v_cvt_f32_u32 v16, v12
    v_mul_f32 v16, 1048576000, v16
    s_lshl_b32 s89, s76, 7
    s_mov_b32 s90, 3207688728
    s_waitcnt lgkmcnt(8)
    v_readfirstlane_b32 s26, v4
    v_lshlrev_b32 v48, 16, v38
    v_and_b32 v49, 0xffff0000, v38
    v_lshlrev_b32 v50, 16, v39
    v_and_b32 v51, 0xffff0000, v39
    s_cmp_lg_u32 s87, 0
    s_cbranch_scc1 K_GEMM
    s_cmp_eq_u32 s26, 0
    s_cbranch_scc0 K_RESTART
K_GEMM:
    s_waitcnt lgkmcnt(7)
    v_mfma_f32_16x16x32_bf16 v[40:43], v[92:95], v[76:79], 0
    s_waitcnt lgkmcnt(6)
    v_mfma_f32_16x16x32_bf16 v[44:47], v[92:95], v[108:111], 0
    s_waitcnt lgkmcnt(5)
    v_mfma_f32_16x16x32_bf16 v[40:43], v[96:99], v[80:83], v[40:43]
    s_waitcnt lgkmcnt(4)
    v_mfma_f32_16x16x32_bf16 v[44:47], v[96:99], v[112:115], v[44:47]
    s_waitcnt lgkmcnt(3)
    v_mfma_f32_16x16x32_bf16 v[40:43], v[100:103], v[84:87], v[40:43]
    s_waitcnt lgkmcnt(2)
    v_mfma_f32_16x16x32_bf16 v[44:47], v[100:103], v[116:119], v[44:47]
    s_waitcnt lgkmcnt(1)
    v_mfma_f32_16x16x32_bf16 v[40:43], v[104:107], v[88:91], v[40:43]
    s_waitcnt lgkmcnt(0)
    v_mfma_f32_16x16x32_bf16 v[44:47], v[104:107], v[120:123], v[44:47]
    v_mul_f32 v48, v16, v48
    v_mul_f32 v49, v16, v49
    v_mul_f32 v50, v16, v50
    v_mul_f32 v51, v16, v51
    s_nop 3
    v_add_f32 v40, v40, v44
    v_add_f32 v41, v41, v45
    v_add_f32 v42, v42, v46
    v_add_f32 v43, v43, v47
    v_fma_f32 v40, v40, s90, v48
    v_fma_f32 v41, v41, s90, v49
    v_fma_f32 v42, v42, s90, v50
    v_fma_f32 v43, v43, s90, v51
    v_cvt_pk_bf16_f32 v48, v40, v41
    v_cvt_pk_bf16_f32 v49, v42, v43
    buffer_store_dwordx2 v[48:49], v11, s[44:47], s89 offen
K_END:
    s_endpgm
K_IDLE:
    s_waitcnt lgkmcnt(0)
    v_readfirstlane_b32 s26, v4
    s_cmp_lg_u32 s87, 0
    s_cbranch_scc1 K_END
    s_cmp_eq_u32 s26, 0
    s_cbranch_scc0 K_RESTART
    s_endpgm
K_HI1:
    v_subrev_u32 v2, 64, v10
    v_cmp_lt_i32 s[64:65], 0, v2
    v_cmp_lt_i32 s[66:67], 4, v2
    v_cmp_lt_i32 s[68:69], 8, v2
    v_cmp_lt_i32 s[70:71], 12, v2
    v_cmp_lt_i32 vcc, 64, v2
    s_cbranch_vccz K_HI1N
    v_mov_b32 v2, 61696
    ds_write_b32 v2, v5
K_HI1N:
    v_subrev_u32 v80, s91, v80
    v_subrev_u32 v81, s91, v81
    v_subrev_u32 v82, s91, v82
    v_subrev_u32 v83, s91, v83
    v_lshlrev_b32_sdwa v96, 2, v80 dst_sel:BYTE_0 dst_unused:UNUSED_PAD src0_sel:DWORD src1_sel:DWORD
    v_lshlrev_b32_sdwa v97, 2, v81 dst_sel:BYTE_0 dst_unused:UNUSED_PAD src0_sel:DWORD src1_sel:DWORD
    v_lshlrev_b32_sdwa v98, 2, v82 dst_sel:BYTE_0 dst_unused:UNUSED_PAD src0_sel:DWORD src1_sel:DWORD
    v_lshlrev_b32_sdwa v99, 2, v83 dst_sel:BYTE_0 dst_unused:UNUSED_PAD src0_sel:DWORD src1_sel:DWORD
    s_mov_b64 exec, s[64:65]
    ds_add_rtn_u32 v88, v96, v5 offset:61440
    s_mov_b64 exec, s[66:67]
    ds_add_rtn_u32 v89, v97, v5 offset:61440
    s_mov_b64 exec, s[68:69]
    ds_add_rtn_u32 v90, v98, v5 offset:61440
    s_mov_b64 exec, s[70:71]
    ds_add_rtn_u32 v91, v99, v5 offset:61440
    s_mov_b64 exec, -1
    v_lshrrev_b32 v104, 20, v80
    v_add_u32 v104, v104, v9
    v_lshrrev_b32 v105, 20, v81
    v_add_u32 v105, v105, v9
    v_lshrrev_b32 v106, 20, v82
    v_add_u32 v106, v106, v9
    v_lshrrev_b32 v107, 20, v83
    v_add_u32 v107, v107, v9
    s_branch K_HB1
K_HI2:
    v_add_u32 v96, v96, v88
    v_add_u32 v97, v97, v89
    v_add_u32 v98, v98, v90
    v_add_u32 v99, v99, v91
    s_mov_b64 exec, s[64:65]
    ds_write2st64_b32 v96, v80, v104 offset0:0 offset1:64
    s_mov_b64 exec, s[66:67]
    ds_write2st64_b32 v97, v81, v105 offset0:0 offset1:64
    s_mov_b64 exec, s[68:69]
    ds_write2st64_b32 v98, v82, v106 offset0:0 offset1:64
    s_mov_b64 exec, s[70:71]
    ds_write2st64_b32 v99, v83, v107 offset0:0 offset1:64
    s_mov_b64 exec, -1
    s_branch K_HB2
K_VHIA:
    v_subrev_u32 v5, 64, v10
    v_cmp_lt_i32 s[64:65], 0, v5
    v_cmp_lt_i32 s[66:67], 4, v5
    v_cmp_lt_i32 s[68:69], 8, v5
    v_cmp_lt_i32 s[70:71], 12, v5
    v_cmp_lt_i32 vcc, 64, v5
    s_cbranch_vccnz K_VOKA
    v_cndmask_b32 v92, 0, v80, s[64:65]
    v_cndmask_b32 v93, 0, v81, s[66:67]
    v_cndmask_b32 v94, 0, v82, s[68:69]
    v_cndmask_b32 v95, 0, v83, s[70:71]
    v_add3_u32 v4, v4, v92, v93
    v_add3_u32 v4, v4, v94, v95
    s_branch K_VHBA
K_VREA:
    s_sub_u32 s1, s1, 1
    s_cbranch_scc1 K_END
    buffer_load_dwordx4 v[76:79], v56, s[40:43], 0 offen sc1
    buffer_load_dwordx4 v[80:83], v56, s[40:43], 0 offen offset:64 sc1
    s_branch K_VERA
K_PFR:
    s_sub_u32 s1, s1, 1
    s_cbranch_scc1 K_END
    buffer_load_dword v127, v126, s[40:43], 0 offen sc1
    s_waitcnt vmcnt(0)
    s_branch K_PFC
.p2align 4
.type K_TABLE,@object
K_TABLE:
.long 94736, 94800, 0, 40960
.long 94864, 94928, 8, 40964
.long 95008, 95072, 16, 40968
.long 95136, 95200, 24, 40972
.long 95280, 95344, 288, 40976
.long 95408, 95472, 296, 40980
.long 95552, 95616, 304, 40984
.long 95680, 95744, 312, 40988
.long 95840, 95776, 576, 40992
.long 95968, 95904, 584, 40996
.long 96112, 96048, 592, 41000
.long 96240, 96176, 600, 41004
.long 96384, 96320, 864, 41008
.long 96512, 96448, 872, 41012
.long 96656, 96592, 880, 41016
.long 96784, 96720, 888, 41020
.long 94752, 94816, 2176, 43008
.long 94880, 94944, 2184, 43012
.long 94992, 95056, 2192, 43016
.long 95120, 95184, 2200, 43020
.long 95296, 95360, 2464, 43024
.long 95424, 95488, 2472, 43028
.long 95536, 95600, 2480, 43032
.long 95664, 95728, 2488, 43036
.long 95856, 95792, 2752, 43040
.long 95984, 95920, 2760, 43044
.long 96096, 96032, 2768, 43048
.long 96224, 96160, 2776, 43052
.long 96400, 96336, 3040, 43056
.long 96528, 96464, 3048, 43060
.long 96640, 96576, 3056, 43064
.long 96768, 96704, 3064, 43068
.long 94768, 94832, 4096, 45056
.long 94896, 94960, 4104, 45060
.long 95040, 95104, 4112, 45064
.long 95168, 95232, 4120, 45068
.long 95248, 95312, 4384, 45072
.long 95376, 95440, 4392, 45076
.long 95520, 95584, 4400, 45080
.long 95648, 95712, 4408, 45084
.long 95872, 95808, 4672, 45088
.long 96000, 95936, 4680, 45092
.long 96144, 96080, 4688, 45096
.long 96272, 96208, 4696, 45100
.long 96352, 96288, 4960, 45104
.long 96480, 96416, 4968, 45108
.long 96624, 96560, 4976, 45112
.long 96752, 96688, 4984, 45116
.long 94784, 94848, 6272, 47104
.long 94912, 94976, 6280, 47108
.long 95024, 95088, 6288, 47112
.long 95152, 95216, 6296, 47116
.long 95264, 95328, 6560, 47120
.long 95392, 95456, 6568, 47124
.long 95504, 95568, 6576, 47128
.long 95632, 95696, 6584, 47132
.long 95888, 95824, 6848, 47136
.long 96016, 95952, 6856, 47140
.long 96128, 96064, 6864, 47144
.long 96256, 96192, 6872, 47148
.long 96368, 96304, 7136, 47152
.long 96496, 96432, 7144, 47156
.long 96608, 96544, 7152, 47160
.long 96736, 96672, 7160, 47164
.long 0, 78336, 0, 61952
.long 4, 78336, 1, 61952
.long 8, 78340, 0, 61952
.long 12, 78340, 1, 61952
.long 16, 78336, 2, 61952
.long 20, 78336, 3, 61952
.long 24, 78340, 2, 61952
.long 28, 78340, 3, 61952
.long 32, 78344, 0, 61968
.long 36, 78344, 1, 61968
.long 40, 78348, 0, 61968
.long 44, 78348, 1, 61968
.long 48, 78344, 2, 61968
.long 52, 78344, 3, 61968
.long 56, 78348, 2, 61968
.long 60, 78348, 3, 61968
.long 64, 78352, 0, 61952
.long 68, 78352, 1, 61952
.long 72, 78356, 0, 61952
.long 76, 78356, 1, 61952
.long 80, 78352, 2, 61952
.long 84, 78352, 3, 61952
.long 88, 78356, 2, 61952
.long 92, 78356, 3, 61952
.long 96, 78360, 0, 61968
.long 100, 78360, 1, 61968
.long 104, 78364, 0, 61968
.long 108, 78364, 1, 61968
.long 112, 78360, 2, 61968
.long 116, 78360, 3, 61968
.long 120, 78364, 2, 61968
.long 124, 78364, 3, 61968
.long 0, 78336, 0, 61952
.long 4, 78336, 1, 61952
.long 8, 78340, 0, 61952
.long 12, 78340, 1, 61952
.long 16, 78336, 2, 61952
.long 20, 78336, 3, 61952
.long 24, 78340, 2, 61952
.long 28, 78340, 3, 61952
.long 32, 78344, 0, 61968
.long 36, 78344, 1, 61968
.long 40, 78348, 0, 61968
.long 44, 78348, 1, 61968
.long 48, 78344, 2, 61968
.long 52, 78344, 3, 61968
.long 56, 78348, 2, 61968
.long 60, 78348, 3, 61968
.long 64, 78352, 0, 61952
.long 68, 78352, 1, 61952
.long 72, 78356, 0, 61952
.long 76, 78356, 1, 61952
.long 80, 78352, 2, 61952
.long 84, 78352, 3, 61952
.long 88, 78356, 2, 61952
.long 92, 78356, 3, 61952
.long 96, 78360, 0, 61968
.long 100, 78360, 1, 61968
.long 104, 78364, 0, 61968
.long 108, 78364, 1, 61968
.long 112, 78360, 2, 61968
.long 116, 78360, 3, 61968
.long 120, 78364, 2, 61968
.long 124, 78364, 3, 61968
.long 1065369472, 0, 0, 61952
.long 0, 1065369472, 8, 61984
.long 1065369472, 0, 16, 62016
.long 0, 1065369472, 24, 62048
.long 0, 0, 32, 62080
.long 0, 0, 40, 62112
.long 0, 0, 48, 62144
.long 0, 0, 56, 62176
.long 1065369472, 0, 0, 62208
.long 0, 1065369472, 8, 62240
.long 1065369472, 0, 16, 62272
.long 0, 1065369472, 24, 62304
.long 0, 0, 32, 62336
.long 0, 0, 40, 62368
.long 0, 0, 48, 62400
.long 0, 0, 56, 62432
.long 1065369472, 0, 32, 61952
.long 0, 1065369472, 40, 61984
.long 1065369472, 0, 48, 62016
.long 0, 1065369472, 56, 62048
.long 0, 0, 0, 62080
.long 0, 0, 8, 62112
.long 0, 0, 16, 62144
.long 0, 0, 24, 62176
.long 1065369472, 0, 32, 62208
.long 0, 1065369472, 40, 62240
.long 1065369472, 0, 48, 62272
.long 0, 1065369472, 56, 62304
.long 0, 0, 0, 62336
.long 0, 0, 8, 62368
.long 0, 0, 16, 62400
.long 0, 0, 24, 62432
.long 0, 0, 0, 61952
.long 0, 0, 8, 61984
.long 0, 0, 16, 62016
.long 0, 0, 24, 62048
.long 1065369472, 0, 32, 62080
.long 0, 1065369472, 40, 62112
.long 1065369472, 0, 48, 62144
.long 0, 1065369472, 56, 62176
.long 0, 0, 0, 62208
.long 0, 0, 8, 62240
.long 0, 0, 16, 62272
.long 0, 0, 24, 62304
.long 1065369472, 0, 32, 62336
.long 0, 1065369472, 40, 62368
.long 1065369472, 0, 48, 62400
.long 0, 1065369472, 56, 62432
.long 0, 0, 32, 61952
.long 0, 0, 40, 61984
.long 0, 0, 48, 62016
.long 0, 0, 56, 62048
.long 1065369472, 0, 0, 62080
.long 0, 1065369472, 8, 62112
.long 1065369472, 0, 16, 62144
.long 0, 1065369472, 24, 62176
.long 0, 0, 32, 62208
.long 0, 0, 40, 62240
.long 0, 0, 48, 62272
.long 0, 0, 56, 62304
.long 1065369472, 0, 0, 62336
.long 0, 1065369472, 8, 62368
.long 1065369472, 0, 16, 62400
.long 0, 1065369472, 24, 62432
.long 4294967280, 1024, 4294967280, 1024
.long 4294967280, 1024, 4294967280, 1024
.long 4294967280, 1024, 4294967280, 1024
.long 4294967280, 1024, 4294967280, 1024
.long 0, 128, 64, 192
.long 8, 136, 72, 200
.long 16, 144, 80, 208
.long 24, 152, 88, 216
.long 4294967280, 1024, 4294967280, 1024
.long 4294967280, 1024, 4294967280, 1024
.long 4294967280, 1024, 4294967280, 1024
.long 4294967280, 1024, 4294967280, 1024
.long 320, 448, 256, 384
.long 328, 456, 264, 392
.long 336, 464, 272, 400
.long 344, 472, 280, 408
.long 4294967280, 1024, 4294967280, 1024
.long 4294967280, 1024, 4294967280, 1024
.long 4294967280, 1024, 4294967280, 1024
.long 4294967280, 1024, 4294967280, 1024
.long 32, 160, 96, 224
.long 40, 168, 104, 232
.long 48, 176, 112, 240
.long 56, 184, 120, 248
.long 4294967280, 1024, 4294967280, 1024
.long 4294967280, 1024, 4294967280, 1024
.long 4294967280, 1024, 4294967280, 1024
.long 4294967280, 1024, 4294967280, 1024
.long 352, 480, 288, 416
.long 360, 488, 296, 424
.long 368, 496, 304, 432
.long 376, 504, 312, 440
.long 4294967280, 1024, 4294967280, 1024
.long 4294967280, 1024, 4294967280, 1024
.long 4294967280, 1024, 4294967280, 1024
.long 4294967280, 1024, 4294967280, 1024
.long 512, 640, 576, 704
.long 520, 648, 584, 712
.long 528, 656, 592, 720
.long 536, 664, 600, 728
.long 4294967280, 1024, 4294967280, 1024
.long 4294967280, 1024, 4294967280, 1024
.long 4294967280, 1024, 4294967280, 1024
.long 4294967280, 1024, 4294967280, 1024
.long 832, 960, 768, 896
.long 840, 968, 776, 904
.long 848, 976, 784, 912
.long 856, 984, 792, 920
.long 4294967280, 1024, 4294967280, 1024
.long 4294967280, 1024, 4294967280, 1024
.long 4294967280, 1024, 4294967280, 1024
.long 4294967280, 1024, 4294967280, 1024
.long 544, 672, 608, 736
.long 552, 680, 616, 744
.long 560, 688, 624, 752
.long 568, 696, 632, 760
.long 4294967280, 1024, 4294967280, 1024
.long 4294967280, 1024, 4294967280, 1024
.long 4294967280, 1024, 4294967280, 1024
.long 4294967280, 1024, 4294967280, 1024
.long 864, 992, 800, 928
.long 872, 1000, 808, 936
.long 880, 1008, 816, 944
.long 888, 1016, 824, 952
.size K_TABLE, 4096
K_HOT_END:
K_RESTART:
    s_mov_b32 s87, 1
    s_mov_b32 s86, 0
    s_waitcnt lgkmcnt(0)
    s_barrier
    v_mov_b64 v[104:105], 0
    v_mov_b64 v[106:107], 0
    v_mov_b32 v6, 0
    v_mov_b32 v7, 0
    v_lshlrev_b32 v4, 4, v0
    ds_write_b128 v4, v[104:107]
    ds_write_b128 v4, v[104:107] offset:16384
    v_lshlrev_b32 v5, 3, v0
    ds_write_b64 v5, v[104:105] offset:32768
    v_lshrrev_b32 v9, 2, v0
    s_lshl_b32 s90, s76, 4
    s_add_u32 s90, s90, 2641920
    v_lshl_add_u32 v126, v9, 12, s90
    v_and_b32 v57, 48, v8
    v_mul_u32_u24 v56, 10240, v9
    v_add_u32 v56, v56, v57
    v_mul_u32_u24 v9, 2500, v9
    s_branch K_POLL1B
K_POLLB:
    s_mov_b64 exec, vcc
K_POLL1B:
    buffer_load_dwordx3 v[10:12], v126, s[40:43], 0 offen sc1
    s_sub_u32 s1, s1, 1
    s_cbranch_scc1 K_END
K_POLL2B:
    s_waitcnt vmcnt(0)
K_POLL3B:
    v_cmp_ne_u32 vcc, s91, v11
    s_cbranch_vccnz K_POLLB
    s_mov_b64 exec, -1
    v_add_u32_sdwa v56, v56, v10 dst_sel:DWORD dst_unused:UNUSED_PAD src0_sel:DWORD src1_sel:WORD_0
    v_lshrrev_b32 v10, 16, v10
    buffer_load_dwordx4 v[76:79], v56, s[40:43], 0 offen sc1
    v_cmp_lt_u32 vcc, 64, v10
    v_sub_u32 v10, v10, v57
    s_cmp_lg_u64 vcc, 0
    s_cselect_b32 s77, 1, 0
    s_cbranch_scc0 K_NOHIB
    s_mov_b64 exec, vcc
    buffer_load_dwordx4 v[80:83], v56, s[40:43], 0 offen offset:64 sc1
    s_mov_b64 exec, -1
K_NOHIB:
    v_cmp_lt_i32 s[56:57], 0, v10
    v_cmp_lt_i32 s[58:59], 4, v10
    v_cmp_lt_i32 s[60:61], 8, v10
    v_cmp_lt_i32 s[62:63], 12, v10
    s_waitcnt vmcnt(0)
    v_subrev_u32 v76, s91, v76
    v_subrev_u32 v77, s91, v77
    v_subrev_u32 v78, s91, v78
    v_subrev_u32 v79, s91, v79
    v_and_b32 v126, 0x3fc, v0
    v_lshlrev_b32 v126, 4, v126
    v_add_u32 v126, 2625536, v126
K_ROUND:
    v_mov_b32 v92, 1048512
    v_mov_b32 v93, 1048512
    v_mov_b64 v[94:95], v[92:93]
    v_mov_b32 v96, 134217727
    v_mov_b32 v97, 134217727
    v_mov_b64 v[98:99], v[96:97]
    v_lshlrev_b32 v4, 4, v0
    v_add_u32 v4, 61952, v4
    v_mov_b32 v100, 0
    v_lshlrev_b32 v5, 2, v1
    ds_write_b128 v4, v[92:95]
    ds_write_b128 v4, v[96:99] offset:16384
    ds_write2st64_b32 v5, v100, v100 offset0:240 offset1:241
    s_waitcnt vmcnt(0) lgkmcnt(0)
    s_barrier
    s_branch K_PASS1
K_GOSLOW:
    s_mov_b32 s48, s8
    s_and_b32 s49, s9, 0xffff
    s_mov_b32 s50, 2560000
    s_mov_b32 s51, 0x20000
    s_mov_b32 s52, s10
    s_and_b32 s53, s11, 0xffff
    s_mov_b32 s54, 2560000
    s_mov_b32 s55, 0x20000
    s_mov_b32 s86, 1
    s_mov_b32 s88, -1
K_NEXTCHUNK:
    s_add_u32 s88, s88, 1
    s_cmp_lt_u32 s88, 256
    s_cbranch_scc0 K_FIN
    s_waitcnt vmcnt(0) lgkmcnt(0)
    s_barrier
    s_mul_i32 s89, s88, 10000
    v_lshlrev_b32 v2, 2, v0
    buffer_load_dword v84, v2, s[52:55], s89 offen
    buffer_load_dword v88, v2, s[48:51], s89 offen
    s_add_u32 s89, s89, 4096
    buffer_load_dword v85, v2, s[52:55], s89 offen
    buffer_load_dword v89, v2, s[48:51], s89 offen
    s_add_u32 s89, s89, 4096
    buffer_load_dword v86, v2, s[52:55], s89 offen
    buffer_load_dword v90, v2, s[48:51], s89 offen
    s_add_u32 s89, s89, 4096
    s_mul_i32 s89, s88, 2500
    s_movk_i32 s90, 2500
    v_mov_b32 v9, s89
    v_mov_b32 v79, 0
    s_mov_b64 s[62:63], 0
    s_mov_b32 s77, 0
    s_waitcnt vmcnt(0)
    v_add_u32 v3, 0, v0
    v_lshrrev_b32 v4, 8, v84
    v_lshl_or_b32 v4, v88, 6, v4
    v_lshl_or_b32 v76, v3, 20, v4
    v_and_b32 v84, 255, v84
    v_cmp_eq_u32 vcc, s76, v84
    v_cmp_gt_u32 s[26:27], s90, v3
    s_and_b64 s[56:57], vcc, s[26:27]
    v_add_u32 v3, 1024, v0
    v_lshrrev_b32 v4, 8, v85
    v_lshl_or_b32 v4, v89, 6, v4
    v_lshl_or_b32 v77, v3, 20, v4
    v_and_b32 v85, 255, v85
    v_cmp_eq_u32 vcc, s76, v85
    v_cmp_gt_u32 s[26:27], s90, v3
    s_and_b64 s[58:59], vcc, s[26:27]
    v_add_u32 v3, 2048, v0
    v_lshrrev_b32 v4, 8, v86
    v_lshl_or_b32 v4, v90, 6, v4
    v_lshl_or_b32 v78, v3, 20, v4
    v_and_b32 v86, 255, v86
    v_cmp_eq_u32 vcc, s76, v86
    v_cmp_gt_u32 s[26:27], s90, v3
    s_and_b64 s[60:61], vcc, s[26:27]
    s_branch K_ROUND
.p2align 6
K_LOOP_S:
    s_waitcnt vmcnt(1)
    ds_read_b64_tr_b16 v[76:77], v26 offset:0
    ds_read_b64_tr_b16 v[78:79], v26 offset:1040
    ds_read_b64_tr_b16 v[80:81], v26 offset:2080
    ds_read_b64_tr_b16 v[82:83], v26 offset:3120
    ds_read_b64_tr_b16 v[84:85], v27 offset:0
    ds_read_b64_tr_b16 v[86:87], v27 offset:1040
    ds_read_b64_tr_b16 v[88:89], v27 offset:2080
    ds_read_b64_tr_b16 v[90:91], v27 offset:3120
    ds_read_b64_tr_b16 v[92:93], v28 offset:0
    ds_read_b64_tr_b16 v[94:95], v28 offset:1040
    ds_read_b64_tr_b16 v[96:97], v28 offset:2080
    ds_read_b64_tr_b16 v[98:99], v28 offset:3120
    ds_read_b64_tr_b16 v[100:101], v29 offset:0
    ds_read_b64_tr_b16 v[102:103], v29 offset:1040
    ds_read_b64_tr_b16 v[104:105], v29 offset:2080
    ds_read_b64_tr_b16 v[106:107], v29 offset:3120
    s_cmp_gt_u32 s84, 2
    s_cbranch_scc0 K_PRIO_S
K_PB_S:
    s_waitcnt vmcnt(0) lgkmcnt(8)
    v_mfma_f32_32x32x16_bf16 v[76:91], v[56:59], v[60:63], v[76:91]
    s_waitcnt lgkmcnt(0)
    v_mfma_f32_32x32x16_bf16 v[92:107], v[56:59], v[64:67], v[92:107]
    buffer_load_dwordx4 v30, s[32:35], s79 idxen offset:0 sc1 lds
    buffer_load_dwordx4 v31, s[32:35], s80 idxen offset:1040 sc1 lds
    buffer_load_dwordx4 v32, s[32:35], s81 idxen offset:2080 sc1 lds
    buffer_load_dwordx4 v33, s[32:35], 0 idxen offset:3120 sc1 lds
    ds_read_b128 v[30:33], v14
    ds_read_b32 v16, v15
    s_lshr_b32 s3, s3, 1
    s_sub_u32 s84, s84, 1
    s_nop 1
    v_exp_f32 v108, v76
    v_exp_f32 v109, v77
    v_exp_f32 v110, v78
    v_exp_f32 v111, v79
    v_exp_f32 v112, v80
    v_exp_f32 v113, v81
    v_exp_f32 v114, v82
    v_exp_f32 v115, v83
    v_exp_f32 v116, v84
    v_exp_f32 v117, v85
    v_exp_f32 v118, v86
    v_exp_f32 v119, v87
    v_exp_f32 v120, v88
    v_exp_f32 v121, v89
    v_exp_f32 v122, v90
    v_exp_f32 v123, v91
    v_mov_b32_dpp v17, v17 row_shl:1 row_mask:0xf bank_mask:0xf bound_ctrl:0
    v_pk_add_f32 v[108:109], v[108:109], 1.0 op_sel_hi:[1,0]
    v_pk_add_f32 v[110:111], v[110:111], 1.0 op_sel_hi:[1,0]
    v_pk_add_f32 v[112:113], v[112:113], 1.0 op_sel_hi:[1,0]
    v_pk_add_f32 v[114:115], v[114:115], 1.0 op_sel_hi:[1,0]
    v_pk_add_f32 v[116:117], v[116:117], 1.0 op_sel_hi:[1,0]
    v_pk_add_f32 v[118:119], v[118:119], 1.0 op_sel_hi:[1,0]
    v_pk_add_f32 v[120:121], v[120:121], 1.0 op_sel_hi:[1,0]
    v_pk_add_f32 v[122:123], v[122:123], 1.0 op_sel_hi:[1,0]
    v_rcp_f32 v108, v108
    v_rcp_f32 v109, v109
    v_rcp_f32 v110, v110
    v_rcp_f32 v111, v111
    v_rcp_f32 v112, v112
    v_rcp_f32 v113, v113
    v_rcp_f32 v114, v114
    v_rcp_f32 v115, v115
    v_rcp_f32 v116, v116
    v_rcp_f32 v117, v117
    v_rcp_f32 v118, v118
    v_rcp_f32 v119, v119
    v_rcp_f32 v120, v120
    v_rcp_f32 v121, v121
    v_rcp_f32 v122, v122
    v_rcp_f32 v123, v123
    v_pk_fma_f32 v[48:49], v[76:77], v[108:109], v[48:49]
    v_pk_fma_f32 v[48:49], v[78:79], v[110:111], v[48:49]
    v_pk_fma_f32 v[48:49], v[80:81], v[112:113], v[48:49]
    v_pk_fma_f32 v[48:49], v[82:83], v[114:115], v[48:49]
    v_pk_fma_f32 v[48:49], v[84:85], v[116:117], v[48:49]
    v_pk_fma_f32 v[48:49], v[86:87], v[118:119], v[48:49]
    v_pk_fma_f32 v[48:49], v[88:89], v[120:121], v[48:49]
    v_pk_fma_f32 v[48:49], v[90:91], v[122:123], v[48:49]
    v_exp_f32 v108, v92
    v_exp_f32 v109, v93
    v_exp_f32 v110, v94
    v_exp_f32 v111, v95
    v_exp_f32 v112, v96
    v_exp_f32 v113, v97
    v_exp_f32 v114, v98
    v_exp_f32 v115, v99
    v_exp_f32 v116, v100
    v_exp_f32 v117, v101
    v_exp_f32 v118, v102
    v_exp_f32 v119, v103
    v_exp_f32 v120, v104
    v_exp_f32 v121, v105
    v_exp_f32 v122, v106
    v_exp_f32 v123, v107
    v_pk_add_f32 v[108:109], v[108:109], 1.0 op_sel_hi:[1,0]
    v_pk_add_f32 v[110:111], v[110:111], 1.0 op_sel_hi:[1,0]
    v_pk_add_f32 v[112:113], v[112:113], 1.0 op_sel_hi:[1,0]
    v_pk_add_f32 v[114:115], v[114:115], 1.0 op_sel_hi:[1,0]
    v_pk_add_f32 v[116:117], v[116:117], 1.0 op_sel_hi:[1,0]
    v_pk_add_f32 v[118:119], v[118:119], 1.0 op_sel_hi:[1,0]
    v_pk_add_f32 v[120:121], v[120:121], 1.0 op_sel_hi:[1,0]
    v_pk_add_f32 v[122:123], v[122:123], 1.0 op_sel_hi:[1,0]
    v_rcp_f32 v108, v108
    v_rcp_f32 v109, v109
    v_rcp_f32 v110, v110
    v_rcp_f32 v111, v111
    v_rcp_f32 v112, v112
    v_rcp_f32 v113, v113
    v_rcp_f32 v114, v114
    v_rcp_f32 v115, v115
    v_rcp_f32 v116, v116
    v_rcp_f32 v117, v117
    v_rcp_f32 v118, v118
    v_rcp_f32 v119, v119
    v_rcp_f32 v120, v120
    v_rcp_f32 v121, v121
    v_rcp_f32 v122, v122
    v_rcp_f32 v123, v123
    v_pk_fma_f32 v[50:51], v[92:93], v[108:109], v[50:51]
    v_pk_fma_f32 v[50:51], v[94:95], v[110:111], v[50:51]
    v_pk_fma_f32 v[50:51], v[96:97], v[112:113], v[50:51]
    v_pk_fma_f32 v[50:51], v[98:99], v[114:115], v[50:51]
    v_pk_fma_f32 v[50:51], v[100:101], v[116:117], v[50:51]
    v_pk_fma_f32 v[50:51], v[102:103], v[118:119], v[50:51]
    v_pk_fma_f32 v[50:51], v[104:105], v[120:121], v[50:51]
    v_pk_fma_f32 v[50:51], v[106:107], v[122:123], v[50:51]
    s_waitcnt lgkmcnt(0)
    v_and_or_b32 v30, v30, s82, v24
    v_and_or_b32 v31, v31, s82, v24
    v_and_or_b32 v32, v32, s82, v24
    v_and_or_b32 v33, v33, s82, v24
    v_cmp_gt_u32 vcc, s38, v16
    s_waitcnt vmcnt(0)
    ds_read_b64_tr_b16 v[76:77], v26 offset:0
    ds_read_b64_tr_b16 v[78:79], v26 offset:1040
    ds_read_b64_tr_b16 v[80:81], v26 offset:2080
    ds_read_b64_tr_b16 v[82:83], v26 offset:3120
    ds_read_b64_tr_b16 v[84:85], v27 offset:0
    ds_read_b64_tr_b16 v[86:87], v27 offset:1040
    ds_read_b64_tr_b16 v[88:89], v27 offset:2080
    ds_read_b64_tr_b16 v[90:91], v27 offset:3120
    ds_read_b64_tr_b16 v[92:93], v28 offset:0
    ds_read_b64_tr_b16 v[94:95], v28 offset:1040
    ds_read_b64_tr_b16 v[96:97], v28 offset:2080
    ds_read_b64_tr_b16 v[98:99], v28 offset:3120
    ds_read_b64_tr_b16 v[100:101], v29 offset:0
    ds_read_b64_tr_b16 v[102:103], v29 offset:1040
    ds_read_b64_tr_b16 v[104:105], v29 offset:2080
    ds_read_b64_tr_b16 v[106:107], v29 offset:3120
    s_cmp_eq_u32 s84, 0
    s_waitcnt lgkmcnt(8)
    v_mfma_f32_32x32x16_bf16 v[76:91], v[56:59], v[68:71], v[76:91]
    s_waitcnt lgkmcnt(0)
    v_mfma_f32_32x32x16_bf16 v[92:107], v[56:59], v[72:75], v[92:107]
    s_cbranch_scc1 K_TL_S
    buffer_load_dwordx4 v30, s[28:31], s79 idxen offset:0 sc1 lds
    buffer_load_dwordx4 v31, s[28:31], s80 idxen offset:1040 sc1 lds
    buffer_load_dwordx4 v32, s[28:31], s81 idxen offset:2080 sc1 lds
    buffer_load_dwordx4 v33, s[28:31], 0 idxen offset:3120 sc1 lds
    buffer_load_dwordx2 v[56:57], v16, s[36:39], 0 idxen
    v_cndmask_b32 v58, 0, v22, vcc
    v_cndmask_b32 v59, 0, v23, vcc
    v_add_u32 v14, 32, v14
    v_add_u32 v15, 32, v15
K_TB_S:
    v_exp_f32 v108, v76
    v_exp_f32 v109, v77
    v_exp_f32 v110, v78
    v_exp_f32 v111, v79
    v_exp_f32 v112, v80
    v_exp_f32 v113, v81
    v_exp_f32 v114, v82
    v_exp_f32 v115, v83
    v_exp_f32 v116, v84
    v_exp_f32 v117, v85
    v_exp_f32 v118, v86
    v_exp_f32 v119, v87
    v_exp_f32 v120, v88
    v_exp_f32 v121, v89
    v_exp_f32 v122, v90
    v_exp_f32 v123, v91
    v_pk_add_f32 v[108:109], v[108:109], 1.0 op_sel_hi:[1,0]
    v_pk_add_f32 v[110:111], v[110:111], 1.0 op_sel_hi:[1,0]
    v_pk_add_f32 v[112:113], v[112:113], 1.0 op_sel_hi:[1,0]
    v_pk_add_f32 v[114:115], v[114:115], 1.0 op_sel_hi:[1,0]
    v_pk_add_f32 v[116:117], v[116:117], 1.0 op_sel_hi:[1,0]
    v_pk_add_f32 v[118:119], v[118:119], 1.0 op_sel_hi:[1,0]
    v_pk_add_f32 v[120:121], v[120:121], 1.0 op_sel_hi:[1,0]
    v_pk_add_f32 v[122:123], v[122:123], 1.0 op_sel_hi:[1,0]
    v_rcp_f32 v108, v108
    v_rcp_f32 v109, v109
    v_rcp_f32 v110, v110
    v_rcp_f32 v111, v111
    v_rcp_f32 v112, v112
    v_rcp_f32 v113, v113
    v_rcp_f32 v114, v114
    v_rcp_f32 v115, v115
    v_rcp_f32 v116, v116
    v_rcp_f32 v117, v117
    v_rcp_f32 v118, v118
    v_rcp_f32 v119, v119
    v_rcp_f32 v120, v120
    v_rcp_f32 v121, v121
    v_rcp_f32 v122, v122
    v_rcp_f32 v123, v123
    v_pk_fma_f32 v[52:53], v[76:77], v[108:109], v[52:53]
    v_pk_fma_f32 v[52:53], v[78:79], v[110:111], v[52:53]
    v_pk_fma_f32 v[52:53], v[80:81], v[112:113], v[52:53]
    v_pk_fma_f32 v[52:53], v[82:83], v[114:115], v[52:53]
    v_pk_fma_f32 v[52:53], v[84:85], v[116:117], v[52:53]
    v_pk_fma_f32 v[52:53], v[86:87], v[118:119], v[52:53]
    v_pk_fma_f32 v[52:53], v[88:89], v[120:121], v[52:53]
    v_pk_fma_f32 v[52:53], v[90:91], v[122:123], v[52:53]
    v_exp_f32 v108, v92
    v_exp_f32 v109, v93
    v_exp_f32 v110, v94
    v_exp_f32 v111, v95
    v_exp_f32 v112, v96
    v_exp_f32 v113, v97
    v_exp_f32 v114, v98
    v_exp_f32 v115, v99
    v_exp_f32 v116, v100
    v_exp_f32 v117, v101
    v_exp_f32 v118, v102
    v_exp_f32 v119, v103
    v_exp_f32 v120, v104
    v_exp_f32 v121, v105
    v_exp_f32 v122, v106
    v_exp_f32 v123, v107
    v_pk_add_f32 v[108:109], v[108:109], 1.0 op_sel_hi:[1,0]
    v_pk_add_f32 v[110:111], v[110:111], 1.0 op_sel_hi:[1,0]
    v_pk_add_f32 v[112:113], v[112:113], 1.0 op_sel_hi:[1,0]
    v_pk_add_f32 v[114:115], v[114:115], 1.0 op_sel_hi:[1,0]
    v_pk_add_f32 v[116:117], v[116:117], 1.0 op_sel_hi:[1,0]
    v_pk_add_f32 v[118:119], v[118:119], 1.0 op_sel_hi:[1,0]
    v_pk_add_f32 v[120:121], v[120:121], 1.0 op_sel_hi:[1,0]
    v_pk_add_f32 v[122:123], v[122:123], 1.0 op_sel_hi:[1,0]
    v_rcp_f32 v108, v108
    v_rcp_f32 v109, v109
    v_rcp_f32 v110, v110
    v_rcp_f32 v111, v111
    v_rcp_f32 v112, v112
    v_rcp_f32 v113, v113
    v_rcp_f32 v114, v114
    v_rcp_f32 v115, v115
    v_rcp_f32 v116, v116
    v_rcp_f32 v117, v117
    v_rcp_f32 v118, v118
    v_rcp_f32 v119, v119
    v_rcp_f32 v120, v120
    v_rcp_f32 v121, v121
    v_rcp_f32 v122, v122
    v_rcp_f32 v123, v123
    v_pk_fma_f32 v[54:55], v[92:93], v[108:109], v[54:55]
    v_pk_fma_f32 v[54:55], v[94:95], v[110:111], v[54:55]
    v_pk_fma_f32 v[54:55], v[96:97], v[112:113], v[54:55]
    v_pk_fma_f32 v[54:55], v[98:99], v[114:115], v[54:55]
    v_pk_fma_f32 v[54:55], v[100:101], v[116:117], v[54:55]
    v_pk_fma_f32 v[54:55], v[102:103], v[118:119], v[54:55]
    v_pk_fma_f32 v[54:55], v[104:105], v[120:121], v[54:55]
    v_pk_fma_f32 v[54:55], v[106:107], v[122:123], v[54:55]
    s_cmp_eq_u32 s84, 0
    s_cbranch_scc1 K_LAST_S
    s_bitcmp1_b32 s3, 0
    s_cbranch_scc0 K_LOOP_S
    v_mov_b32_dpp v34, v17 row_newbcast:0 row_mask:0xf bank_mask:0xf
    v_mov_b32_dpp v35, v17 row_newbcast:0 row_mask:0xf bank_mask:0xf
    v_cvt_f64_f32 v[108:109], v48
    v_cvt_f64_f32 v[110:111], v49
    v_permlane16_swap_b32 v34, v35
    v_cvt_f64_f32 v[112:113], v50
    v_cvt_f64_f32 v[114:115], v51
    v_add_u32 v34, v34, v18
    v_add_u32 v35, v35, v18
    v_cvt_f64_f32 v[116:117], v52
    v_cvt_f64_f32 v[118:119], v53
    v_cvt_f64_f32 v[120:121], v54
    v_cvt_f64_f32 v[122:123], v55
    ds_read_b32 v62, v34 offset:40960
    ds_read_b32 v63, v35 offset:40960
    ds_read_b32 v66, v34 offset:41088
    ds_read_b32 v67, v35 offset:41088
    ds_read_b32 v70, v34 offset:41216
    ds_read_b32 v71, v35 offset:41216
    ds_read_b32 v74, v34 offset:41344
    ds_read_b32 v75, v35 offset:41344
    ds_add_f64 v36, v[108:109] offset:0
    ds_add_f64 v37, v[110:111] offset:0
    ds_add_f64 v36, v[112:113] offset:256
    ds_add_f64 v37, v[114:115] offset:256
    ds_add_f64 v36, v[116:117] offset:512
    ds_add_f64 v37, v[118:119] offset:512
    ds_add_f64 v36, v[120:121] offset:768
    ds_add_f64 v37, v[122:123] offset:768
    v_mov_b64 v[48:49], 0
    v_mov_b64 v[50:51], 0
    v_mov_b64 v[52:53], 0
    v_mov_b64 v[54:55], 0
    v_lshlrev_b32 v36, 1, v34
    v_lshlrev_b32 v37, 1, v35
    s_branch K_LOOP_S
K_PRIO_S:
    s_setprio 2
    s_cmp_gt_u32 s84, 1
    s_cbranch_scc1 K_PB_S
    s_setprio 1
    s_branch K_PB_S
K_TL_S:
    s_setprio 0
    global_load_lds_dwordx4 v4, s[16:17]
    s_mov_b32 s85, 1
    s_nop 5
    s_branch K_TB_S
K_LAST_S:
    v_cvt_f64_f32 v[108:109], v48
    v_cvt_f64_f32 v[110:111], v49
    v_cvt_f64_f32 v[112:113], v50
    v_cvt_f64_f32 v[114:115], v51
    v_cvt_f64_f32 v[116:117], v52
    v_cvt_f64_f32 v[118:119], v53
    v_cvt_f64_f32 v[120:121], v54
    v_cvt_f64_f32 v[122:123], v55
    ds_add_f64 v36, v[108:109] offset:0
    ds_add_f64 v37, v[110:111] offset:0
    ds_add_f64 v36, v[112:113] offset:256
    ds_add_f64 v37, v[114:115] offset:256
    ds_add_f64 v36, v[116:117] offset:512
    ds_add_f64 v37, v[118:119] offset:512
    ds_add_f64 v36, v[120:121] offset:768
    ds_add_f64 v37, v[122:123] offset:768
    s_branch K_DONE
.section .rodata,"a"
.p2align 6
.amdhsa_kernel gather_scatter__edge_featured_mpnn_mpnn__graph_kernel
  .amdhsa_next_free_vgpr 128
  .amdhsa_next_free_sgpr 96
  .amdhsa_accum_offset 128
  .amdhsa_group_segment_fixed_size 0
  .amdhsa_kernarg_size 88
  .amdhsa_user_sgpr_count 2
  .amdhsa_user_sgpr_kernarg_segment_ptr 1
  .amdhsa_system_sgpr_workgroup_id_x 1
  .amdhsa_float_denorm_mode_32 3
.end_amdhsa_kernel
```
